```python
import torch

def _softmax(x, axis=-1):
    return torch.softmax(x, dim=axis)
def _gelu(x):
    return torch.nn.functional.gelu(x, approximate="tanh")
def _silu(x):
    return torch.nn.functional.silu(x)
def _sigmoid(x):
    return torch.sigmoid(x)
def _layernorm(x, axis=-1, eps=1e-5):
    m = x.mean(dim=axis, keepdim=True)
    v = x.var(dim=axis, keepdim=True, unbiased=False)
    return (x - m) / torch.sqrt(v + eps)
def _scatter_add(tgt, idx, src, axis=0):
    return tgt.clone().index_add_(axis, idx, src)
def _segment_sum(src, seg, n):
    out = torch.zeros((n,) + src.shape[1:], dtype=src.dtype)
    return out.index_add_(0, seg, src)
def _pad(x, pw):
    flat = tuple(v for pair in reversed(pw) for v in pair)
    return torch.nn.functional.pad(x, flat)

kernel_name = 'concat_heads__gqa_block_cached__mha_block_cached__near_ridge'

def setup_inputs():

    _w = (lambda a: (lambda t: t.to(torch.bfloat16) if t.is_floating_point() else t)(torch.as_tensor(a)))
    def _A_setup():
        B, Sq, D = 8, 96, 640
        Hq, Hkv, Sk, Dh = 32, 32, 512, 192
        assert Hq % Hkv == 0, (Hq, Hkv)
        return {
            "x": _w((lambda *s: torch.randn(*s, dtype=torch.bfloat16) * 0.8)(B, Sq, D)),
            "k_cache": _w((lambda *s: torch.randn(*s, dtype=torch.bfloat16) * 0.8)(B, Hkv, Sk, Dh)),
            "v_cache": _w((lambda *s: torch.randn(*s, dtype=torch.bfloat16) * 0.05)(B, Hkv, Sk, Dh)),
            "wq": _w((lambda *s: torch.randn(*s, dtype=torch.bfloat16) * 0.8)(D, Hq * Dh) * (D ** -0.5)),
            "wo": _w((lambda *s: torch.randn(*s, dtype=torch.bfloat16) * 0.05)(Hq * Dh, D) * ((Hq * Dh) ** -0.5)),
        }
    _A_in = _A_setup()

    def _B_setup():
        B, Sq, D = 8, 96, 640
        H, Sk, Dh = 32, 512, 192
        return {
            "x": _w((lambda *s: torch.randn(*s, dtype=torch.bfloat16) * 0.8)(B, Sq, D)),
            "k_cache": _w((lambda *s: torch.randn(*s, dtype=torch.bfloat16) * 0.8)(B, H, Sk, Dh)),
            "v_cache": _w((lambda *s: torch.randn(*s, dtype=torch.bfloat16) * 0.05)(B, H, Sk, Dh)),
            "wq": _w((lambda *s: torch.randn(*s, dtype=torch.bfloat16) * 0.8)(D, H * Dh) * (D ** -0.5)),
            "wo": _w((lambda *s: torch.randn(*s, dtype=torch.bfloat16) * 0.05)(H * Dh, D) * ((H * Dh) ** -0.5)),
        }
    _B_in = _B_setup()

    return {
        "A_x": _A_in["x"],
        "A_k_cache": _A_in["k_cache"],
        "A_v_cache": _A_in["v_cache"],
        "A_wq": _A_in["wq"],
        "A_wo": _A_in["wo"],
        "B_x": _B_in["x"],
        "B_k_cache": _B_in["k_cache"],
        "B_v_cache": _B_in["v_cache"],
        "B_wq": _B_in["wq"],
        "B_wo": _B_in["wo"],
    }

def reference(A_x, A_k_cache, A_v_cache, A_wq, A_wo, B_x, B_k_cache, B_v_cache, B_wq, B_wo):
    def _A_ref(x, k_cache, v_cache, wq, wo):
        B, Sq, D = x.shape
        Hq, Dh = 32, 192
        Hkv = k_cache.shape[1]
        rep = Hq // Hkv
        q = (lambda x, *d: x.permute(*d))((x @ wq).reshape(B, Sq, Hq, Dh), 0, 2, 1, 3)
        k = (lambda x, n, axis: torch.repeat_interleave(x, n, dim=axis))(k_cache, rep, axis=1)
        v = (lambda x, n, axis: torch.repeat_interleave(x, n, dim=axis))(v_cache, rep, axis=1)
        scores = torch.einsum("bhqd,bhkd->bhqk", q, k) * (Dh ** -0.5)
        p = _softmax(scores, axis=-1)
        o = torch.einsum("bhqk,bhkd->bhqd", p, v)
        return (lambda x, *d: x.permute(*d))(o, 0, 2, 1, 3).reshape(B, Sq, Hq * Dh) @ wo

    def _B_ref(x, k_cache, v_cache, wq, wo):
        B, Sq, D = x.shape
        H, Dh = 32, 192
        q = (lambda x, *d: x.permute(*d))((x @ wq).reshape(B, Sq, H, Dh), 0, 2, 1, 3)
        scores = torch.einsum("bhqd,bhkd->bhqk", q, k_cache) * (Dh ** -0.5)
        p = _softmax(scores, axis=-1)
        o = torch.einsum("bhqk,bhkd->bhqd", p, v_cache)
        return (lambda x, *d: x.permute(*d))(o, 0, 2, 1, 3).reshape(B, Sq, H * Dh) @ wo

    a = _A_ref(A_x, A_k_cache, A_v_cache, A_wq, A_wo)
    b = _B_ref(B_x, B_k_cache, B_v_cache, B_wq, B_wo)
    return torch.concatenate([a, b], axis=-1)
```

```asm
; @launch grid=(256,1,1) block=(256,1,1) lds=147456
.amdgcn_target "amdgcn-amd-amdhsa--gfx950"
.text
.globl concat_heads__gqa_block_cached__mha_block_cached__near_ridge_kernel
.p2align 8
.type concat_heads__gqa_block_cached__mha_block_cached__near_ridge_kernel,@function
concat_heads__gqa_block_cached__mha_block_cached__near_ridge_kernel:
    s_cmp_ge_u32 s2, 256
    s_cbranch_scc1 L_exit
    s_bfe_u32 s55, s2, 0x10002
    s_mul_i32 s3, s55, 40
    s_load_dwordx8 s[4:11], s[0:1], s3
    s_add_u32 s3, s3, 32
    s_load_dwordx2 s[12:13], s[0:1], s3
    s_load_dwordx4 s[20:23], s[0:1], 80
    s_load_dwordx2 s[24:25], s[0:1], 96
    v_lshrrev_b32 v248, 6, v0
    v_and_b32 v240, 63, v0
    s_and_b32 s70, s2, 3
    s_bfe_u32 s53, s2, 0x30003
    s_lshr_b32 s87, s2, 6
    v_readfirstlane_b32 s52, v248
    s_lshl_b32 s54, s70, 2
    s_add_u32 s54, s54, s87
    s_getpc_b64 s[26:27]
L_pc:
    s_sub_u32 s26, s26, L_pc-concat_heads__gqa_block_cached__mha_block_cached__near_ridge_kernel
    s_subb_u32 s27, s27, 0
    s_lshr_b32 s71, s2, 3
    s_lshl_b32 s71, s71, 2
    s_add_u32 s71, s71, s52
    s_mul_i32 s71, s71, 384
    v_and_b32 v245, 3, v240
    v_lshlrev_b32 v245, 7, v245
    v_add_u32 v245, s71, v245
    v_min_u32 v245, L_end-4-concat_heads__gqa_block_cached__mha_block_cached__near_ridge_kernel, v245
    global_load_dword v246, v245, s[26:27]
    s_lshr_b32 s76, s53, 1
    s_cmp_eq_u32 s53, 7
    s_addc_u32 s62, s76, s87
    s_cmp_ge_u32 s62, 5
    s_cselect_b32 s71, 5, 0
    s_sub_u32 s62, s62, s71
    s_lshl_b32 s59, s62, 7
    s_mul_i32 s61, s52, 3072
    s_add_u32 s61, s61, 73728
    s_mul_i32 s70, s52, 24
    v_lshrrev_b32 v248, 3, v240
    v_add_u32 v248, s70, v248
    v_lshrrev_b32 v249, 1, v248
    v_xor_b32 v249, v249, v240
    v_and_b32 v249, 7, v249
    v_mul_u32_u24 v248, 1280, v248
    v_lshl_add_u32 v212, v249, 4, v248
    v_xor_b32 v249, 64, v212
    v_add_u32 v213, 9216, v249
    v_add_u32 v214, 18432, v212
    s_mul_i32 s70, s53, 122880
    s_waitcnt lgkmcnt(0)
    s_add_u32 s28, s4, s70
    s_addc_u32 s29, s5, 0
    s_and_b32 s29, s29, 0xffff
    s_mov_b32 s30, 122880
    s_mov_b32 s31, 0x20000
    s_mov_b32 m0, s61
    s_nop 0
    buffer_load_dwordx4 v212, s[28:31], s59 offen offset:0 lds
    buffer_load_dwordx4 v213, s[28:31], s59 offen offset:1024 lds
    buffer_load_dwordx4 v214, s[28:31], s59 offen offset:2048 lds
    s_mul_i32 s70, s54, 768
    s_add_u32 s32, s10, s70
    s_addc_u32 s33, s11, 0
    s_and_b32 s33, s33, 0xffff
    s_mov_b32 s34, 7852800
    s_mov_b32 s35, 0x20000
    s_mul_i32 s74, s52, 6144
    s_add_u32 s60, s74, 24576
    s_and_b32 s71, s52, 1
    s_lshr_b32 s72, s52, 1
    s_and_b32 s77, s53, 1
    s_mul_i32 s70, s71, 49152
    s_mul_i32 s73, s72, 384
    s_add_u32 s70, s70, s73
    s_mul_i32 s97, s77, 393216
    s_sub_u32 s58, 393216, s97
    s_add_u32 s97, s97, s70
    s_add_u32 s58, s58, s70
    s_mul_i32 s57, s59, 6144
    s_add_u32 s57, s57, s97
    s_movk_i32 s71, 12288
    s_movk_i32 s72, -384
    v_add_u32 v248, 0, v240
    v_mul_u32_u24 v249, 2731, v248
    v_lshrrev_b32 v249, 16, v249
    v_and_b32 v250, 6, v249
    v_xor_b32 v251, v250, v240
    v_lshlrev_b32 v206, 4, v251
    v_and_b32 v250, 12, v249
    v_add_u32 v250, v250, v249
    v_mad_i32_i24 v251, v249, s72, v206
    v_mad_u32_u24 v209, v250, s71, v251
    s_mov_b32 m0, s60
    s_nop 0
    buffer_load_dwordx4 v209, s[32:35], s57 offen offset:0  lds
    v_add_u32 v248, 64, v240
    v_mul_u32_u24 v249, 2731, v248
    v_lshrrev_b32 v249, 16, v249
    v_and_b32 v250, 6, v249
    v_xor_b32 v251, v250, v240
    v_lshlrev_b32 v207, 4, v251
    v_and_b32 v250, 12, v249
    v_add_u32 v250, v250, v249
    v_mad_i32_i24 v251, v249, s72, v207
    v_mad_u32_u24 v210, v250, s71, v251
    buffer_load_dwordx4 v210, s[32:35], s57 offen offset:1024  lds
    v_add_u32 v248, 128, v240
    v_mul_u32_u24 v249, 2731, v248
    v_lshrrev_b32 v249, 16, v249
    v_and_b32 v250, 6, v249
    v_xor_b32 v251, v250, v240
    v_lshlrev_b32 v208, 4, v251
    v_and_b32 v250, 12, v249
    v_add_u32 v250, v250, v249
    v_mad_i32_i24 v251, v249, s72, v208
    v_mad_u32_u24 v211, v250, s71, v251
    buffer_load_dwordx4 v211, s[32:35], s57 offen offset:2048  lds
    s_add_u32 m0, s60, 3072
    s_add_u32 s73, s57, 196608
    buffer_load_dwordx4 v209, s[32:35], s73 offen offset:0  lds
    buffer_load_dwordx4 v210, s[32:35], s73 offen offset:1024  lds
    buffer_load_dwordx4 v211, s[32:35], s73 offen offset:2048  lds
    s_add_u32 s75, s61, 12288
    s_xor_b32 s75, s75, s61
    s_add_u32 s60, s60, 24576
    s_cmp_ge_u32 s60, 73728
    s_cselect_b32 s60, s74, s60
    s_mul_i32 s57, s59, 6144
    s_add_u32 s57, s57, s58
    s_xor_b32 s61, s61, s75
    s_mov_b32 m0, s60
    s_nop 0
    buffer_load_dwordx4 v209, s[32:35], s57 offen offset:0  lds
    buffer_load_dwordx4 v210, s[32:35], s57 offen offset:1024  lds
    buffer_load_dwordx4 v211, s[32:35], s57 offen offset:2048  lds
    s_lshl_b32 s70, s62, 2
    s_mov_b32 s72, 0x21043210
    s_mov_b32 s73, 3
    s_lshr_b64 s[72:73], s[72:73], s70
    s_and_b32 s98, s72, 0xfffff
    s_add_u32 s72, s98, 0x55555
    s_lshr_b32 s99, s72, 12
    s_lshl_b32 s72, s72, 20
    s_or_b32 s98, s98, s72
    s_and_b32 s71, s52, 1
    s_lshr_b32 s72, s52, 1
    s_mul_i32 s64, s72, 196608
    s_mul_i32 s73, s71, 6144
    s_add_u32 s64, s64, s73
    s_mov_b32 s65, s64
    s_add_u32 s66, s74, 98304
    s_add_u32 s67, s74, 122880
    s_add_u32 s88, s53, 2
    s_mov_b32 s91, 0x41000000
    s_lshl_b32 s70, s53, 4
    s_add_u32 s70, s70, s54
    s_mul_i32 s73, s70, 393216
    s_add_u32 s36, s6, s73
    s_addc_u32 s37, s7, 0
    s_and_b32 s37, s37, 0xffff
    s_mov_b32 s38, 393216
    s_mov_b32 s39, 0x20000
    s_add_u32 s40, s8, s73
    s_addc_u32 s41, s9, 0
    s_and_b32 s41, s41, 0xffff
    s_mov_b32 s42, 393216
    s_mov_b32 s43, 0x20000
    s_mul_i32 s73, s54, 491520
    s_add_u32 s44, s12, s73
    s_addc_u32 s45, s13, 0
    s_and_b32 s45, s45, 0xffff
    s_mov_b32 s46, 491520
    s_mov_b32 s47, 0x20000
    s_lshl_b32 s89, s55, 3
    s_add_u32 s89, s89, s53
    s_lshl_b32 s70, s89, 4
    s_add_u32 s70, s70, s54
    s_lshl_b32 s73, s70, 7
    s_add_u32 s73, s73, 33554432
    s_add_u32 s4, s24, s73
    s_addc_u32 s5, s25, 0
    s_and_b32 s5, s5, 0xffff
    s_mov_b32 s6, 128
    s_mov_b32 s7, 0x20000
    s_lshl_b32 s73, s89, 11
    s_add_u32 s73, s73, 33554432
    s_add_u32 s8, s24, s73
    s_addc_u32 s9, s25, 0
    s_and_b32 s9, s9, 0xffff
    s_mov_b32 s10, 2048
    s_mov_b32 s11, 0x20000
    s_add_u32 s12, s24, 33554432
    s_addc_u32 s13, s25, 0
    s_and_b32 s13, s13, 0xffff
    s_mov_b32 s14, 32768
    s_mov_b32 s15, 0x20000
    s_add_u32 s16, s22, 0
    s_addc_u32 s17, s23, 0
    s_and_b32 s17, s17, 0xffff
    s_mov_b32 s18, 128
    s_mov_b32 s19, 0x20000
    s_cmp_eq_u32 s52, 0
    s_cselect_b32 s6, 128, 0
    v_lshlrev_b32 v241, 7, v240
    v_lshlrev_b32 v243, 2, v240
    s_mov_b32 s56, 0x3dd53b95
    s_lshl_b32 s77, s77, 1
    s_cmp_eq_u32 s53, 7
    s_cselect_b32 s76, 4, s76
    s_cselect_b32 s77, 0, s77
    s_xor_b32 s70, s87, 3
    s_add_u32 s70, s76, s70
    s_cmp_ge_u32 s70, 5
    s_cselect_b32 s73, 5, 0
    s_sub_u32 s70, s70, s73
    s_lshl_b32 s78, s70, 8
    s_xor_b32 s70, s87, 1
    s_add_u32 s70, s76, s70
    s_cmp_ge_u32 s70, 5
    s_cselect_b32 s73, 5, 0
    s_sub_u32 s70, s70, s73
    s_lshl_b32 s79, s70, 8
    s_xor_b32 s70, s87, 2
    s_add_u32 s70, s76, s70
    s_cmp_ge_u32 s70, 5
    s_cselect_b32 s73, 5, 0
    s_sub_u32 s70, s70, s73
    s_lshl_b32 s80, s70, 8
    s_mov_b32 s70, 4
    s_add_u32 s70, s76, s70
    s_cmp_ge_u32 s70, 5
    s_cselect_b32 s73, 5, 0
    s_sub_u32 s70, s70, s73
    s_lshl_b32 s81, s70, 8
    s_xor_b32 s70, s87, 0
    s_add_u32 s70, s76, s70
    s_cmp_ge_u32 s70, 5
    s_cselect_b32 s73, 5, 0
    s_sub_u32 s70, s70, s73
    s_lshl_b32 s82, s70, 8
    s_xor_b32 s70, s77, 0
    s_mul_i32 s83, s70, 122880
    s_xor_b32 s70, s77, 1
    s_mul_i32 s84, s70, 122880
    s_xor_b32 s70, s77, 2
    s_mul_i32 s85, s70, 122880
    s_xor_b32 s70, s77, 3
    s_mul_i32 s86, s70, 122880
    s_mul_i32 s70, s72, 12288
    v_add_u32 v248, 0, v240
    v_mul_u32_u24 v249, 2731, v248
    v_lshrrev_b32 v249, 16, v249
    v_bfe_u32 v250, v249, 1, 3
    v_xor_b32 v250, v250, v240
    v_lshlrev_b32 v200, 4, v250
    v_add_u32 v248, 64, v240
    v_mul_u32_u24 v249, 2731, v248
    v_lshrrev_b32 v249, 16, v249
    v_bfe_u32 v250, v249, 1, 3
    v_xor_b32 v250, v250, v240
    v_lshlrev_b32 v201, 4, v250
    v_add_u32 v248, 128, v240
    v_mul_u32_u24 v249, 2731, v248
    v_lshrrev_b32 v249, 16, v249
    v_bfe_u32 v250, v249, 1, 3
    v_xor_b32 v250, v250, v240
    v_lshlrev_b32 v202, 4, v250
    v_add_u32 v248, 192, v240
    v_mul_u32_u24 v249, 2731, v248
    v_lshrrev_b32 v249, 16, v249
    v_bfe_u32 v250, v249, 1, 3
    v_xor_b32 v250, v250, v240
    v_lshlrev_b32 v203, 4, v250
    v_add_u32 v203, 3072, v203
    v_add_u32 v248, 256, v240
    v_mul_u32_u24 v249, 2731, v248
    v_lshrrev_b32 v249, 16, v249
    v_bfe_u32 v250, v249, 1, 3
    v_xor_b32 v250, v250, v240
    v_lshlrev_b32 v204, 4, v250
    v_add_u32 v204, 3072, v204
    v_add_u32 v248, 320, v240
    v_mul_u32_u24 v249, 2731, v248
    v_lshrrev_b32 v249, 16, v249
    v_bfe_u32 v250, v249, 1, 3
    v_xor_b32 v250, v250, v240
    v_lshlrev_b32 v205, 4, v250
    v_add_u32 v205, 3072, v205
    v_and_b32 v248, 15, v240
    v_lshrrev_b32 v249, 4, v240
    v_lshrrev_b32 v250, 1, v248
    v_xor_b32 v250, v250, v249
    v_mul_u32_u24 v251, 384, v248
    v_add_u32 v251, s70, v251
    v_add_u32 v251, 98304, v251
    v_lshl_add_u32 v221, v250, 4, v251
    v_xor_b32 v252, 4, v250
    v_lshl_add_u32 v222, v252, 4, v251
    s_mul_i32 s73, s71, 6144
    s_add_u32 s73, s73, 73728
    v_lshlrev_b32 v251, 7, v248
    v_add_u32 v251, s73, v251
    v_lshl_add_u32 v227, v250, 4, v251
    s_and_b32 s73, s53, 1
    s_lshl_b32 s73, s73, 6
    v_xor_b32 v227, s73, v227
    v_xor_b32 v228, 64, v227
    s_mul_i32 s73, s52, 24
    v_lshlrev_b32 v250, 1, v249
    v_xor_b32 v250, v250, v248
    v_add_u32 v251, s73, v249
    v_mul_u32_u24 v251, 1280, v251
    v_lshl_add_u32 v215, v250, 4, v251
    v_xor_b32 v250, 128, v215
    v_add_u32 v216, 4096, v250
    v_add_u32 v217, 8192, v215
    v_add_u32 v218, 15360, v250
    v_add_u32 v219, 19456, v215
    v_add_u32 v220, 23552, v250
    v_lshrrev_b32 v248, 2, v240
    v_and_b32 v249, 3, v240
    v_bfe_u32 v250, v240, 3, 2
    v_mul_u32_u24 v251, 384, v248
    v_lshl_add_u32 v251, v249, 3, v251
    v_add_u32 v251, s70, v251
    v_add_u32 v251, 24576, v251
    v_xor_b32 v252, 0, v250
    v_lshl_add_u32 v223, v252, 5, v251
    v_xor_b32 v252, 1, v250
    v_lshl_add_u32 v224, v252, 5, v251
    v_xor_b32 v252, 2, v250
    v_lshl_add_u32 v225, v252, 5, v251
    v_xor_b32 v252, 3, v250
    v_lshl_add_u32 v226, v252, 5, v251
    v_lshlrev_b32 v251, 8, v248
    v_lshl_add_u32 v251, v249, 3, v251
    v_and_b32 v250, 7, v248
    s_lshl_b32 s73, s52, 1
    v_xor_b32 v250, s73, v250
    v_lshl_add_u32 v229, v250, 5, v251
    v_xor_b32 v232, 32, v229
    v_add_u32 v230, 49152, v229
    v_add_u32 v231, 98304, v229
    v_add_u32 v233, 49152, v232
    v_add_u32 v234, 98304, v232
    v_lshlrev_b32 v248, 4, v240
    s_mul_i32 s73, s52, 3072
    s_add_u32 s73, s73, 73728
    v_add_u32 v235, s73, v248
    s_mul_i32 s73, s77, 3072
    s_add_u32 s73, s73, 73728
    v_add_u32 v236, s73, v248
    v_add_u32 v237, 36864, v236
    s_xor_b32 s73, s77, 2
    s_mul_i32 s73, s73, 3072
    s_add_u32 s73, s73, 73728
    v_add_u32 v198, s73, v248
    v_add_u32 v199, 36864, v198
    v_add_u32 v238, s74, v248
    v_add_u32 v239, 3072, v238
    v_mov_b32 v0, 0
    v_mov_b32 v1, 0
    v_mov_b32 v2, 0
    v_mov_b32 v3, 0
    v_mov_b32 v4, 0
    v_mov_b32 v5, 0
    v_mov_b32 v6, 0
    v_mov_b32 v7, 0
    v_mov_b32 v8, 0
    v_mov_b32 v9, 0
    v_mov_b32 v10, 0
    v_mov_b32 v11, 0
    v_mov_b32 v12, 0
    v_mov_b32 v13, 0
    v_mov_b32 v14, 0
    v_mov_b32 v15, 0
    v_mov_b32 v16, 0
    v_mov_b32 v17, 0
    v_mov_b32 v18, 0
    v_mov_b32 v19, 0
    v_mov_b32 v20, 0
    v_mov_b32 v21, 0
    v_mov_b32 v22, 0
    v_mov_b32 v23, 0
    v_mov_b32 v24, 0
    v_mov_b32 v25, 0
    v_mov_b32 v26, 0
    v_mov_b32 v27, 0
    v_mov_b32 v28, 0
    v_mov_b32 v29, 0
    v_mov_b32 v30, 0
    v_mov_b32 v31, 0
    v_mov_b32 v32, 0
    v_mov_b32 v33, 0
    v_mov_b32 v34, 0
    v_mov_b32 v35, 0
    v_mov_b32 v36, 0
    v_mov_b32 v37, 0
    v_mov_b32 v38, 0
    v_mov_b32 v39, 0
    v_mov_b32 v40, 0
    v_mov_b32 v41, 0
    v_mov_b32 v42, 0
    v_mov_b32 v43, 0
    v_mov_b32 v44, 0
    v_mov_b32 v45, 0
    v_mov_b32 v46, 0
    v_mov_b32 v47, 0
    v_mov_b32 v48, 0
    v_mov_b32 v49, 0
    v_mov_b32 v50, 0
    v_mov_b32 v51, 0
    v_mov_b32 v52, 0
    v_mov_b32 v53, 0
    v_mov_b32 v54, 0
    v_mov_b32 v55, 0
    v_mov_b32 v56, 0
    v_mov_b32 v57, 0
    v_mov_b32 v58, 0
    v_mov_b32 v59, 0
    v_mov_b32 v60, 0
    v_mov_b32 v61, 0
    v_mov_b32 v62, 0
    v_mov_b32 v63, 0
    v_mov_b32 v64, 0
    v_mov_b32 v65, 0
    v_mov_b32 v66, 0
    v_mov_b32 v67, 0
    v_mov_b32 v68, 0
    v_mov_b32 v69, 0
    v_mov_b32 v70, 0
    v_mov_b32 v71, 0
    v_mov_b32 v72, 0
    v_mov_b32 v73, 0
    v_mov_b32 v74, 0
    v_mov_b32 v75, 0
    v_mov_b32 v76, 0
    v_mov_b32 v77, 0
    v_mov_b32 v78, 0
    v_mov_b32 v79, 0
    v_mov_b32 v80, 0
    v_mov_b32 v81, 0
    v_mov_b32 v82, 0
    v_mov_b32 v83, 0
    v_mov_b32 v84, 0
    v_mov_b32 v85, 0
    v_mov_b32 v86, 0
    v_mov_b32 v87, 0
    v_mov_b32 v88, 0
    v_mov_b32 v89, 0
    v_mov_b32 v90, 0
    v_mov_b32 v91, 0
    v_mov_b32 v92, 0
    v_mov_b32 v93, 0
    v_mov_b32 v94, 0
    v_mov_b32 v95, 0
    v_mov_b32 v96, 0
    v_mov_b32 v97, 0
    v_mov_b32 v98, 0
    v_mov_b32 v99, 0
    v_mov_b32 v100, 0
    v_mov_b32 v101, 0
    v_mov_b32 v102, 0
    v_mov_b32 v103, 0
    v_mov_b32 v104, 0
    v_mov_b32 v105, 0
    v_mov_b32 v106, 0
    v_mov_b32 v107, 0
    v_mov_b32 v108, 0
    v_mov_b32 v109, 0
    v_mov_b32 v110, 0
    v_mov_b32 v111, 0
    v_mov_b32 v112, 0
    v_mov_b32 v113, 0
    v_mov_b32 v114, 0
    v_mov_b32 v115, 0
    v_mov_b32 v116, 0
    v_mov_b32 v117, 0
    v_mov_b32 v118, 0
    v_mov_b32 v119, 0
    v_mov_b32 v120, 0
    v_mov_b32 v121, 0
    v_mov_b32 v122, 0
    v_mov_b32 v123, 0
    v_mov_b32 v124, 0
    v_mov_b32 v125, 0
    v_mov_b32 v126, 0
    v_mov_b32 v127, 0
    v_mov_b32 v128, 0
    v_mov_b32 v129, 0
    v_mov_b32 v130, 0
    v_mov_b32 v131, 0
    v_mov_b32 v132, 0
    v_mov_b32 v133, 0
    v_mov_b32 v134, 0
    v_mov_b32 v135, 0
    v_mov_b32 v136, 0
    v_mov_b32 v137, 0
    v_mov_b32 v138, 0
    v_mov_b32 v139, 0
    v_mov_b32 v140, 0
    v_mov_b32 v141, 0
    v_mov_b32 v142, 0
    v_mov_b32 v143, 0
    v_mov_b32 v180, 0xff7fffff
    v_mov_b32 v183, 0
    v_mov_b32 v181, 0xff7fffff
    v_mov_b32 v184, 0
    v_mov_b32 v182, 0xff7fffff
    v_mov_b32 v185, 0
    s_add_u32 s70, s53, s87
    s_and_b32 s70, s70, 7
    s_lshl_b32 s70, s70, 2
    s_lshr_b32 s3, 0x21212121, s70
    s_and_b32 s3, s3, 15
    s_add_u32 s70, s53, s87
    s_and_b32 s70, s70, 7
    s_lshl_b32 s70, s70, 2
    s_lshr_b32 s90, 0x76767676, s70
    s_and_b32 s90, s90, 15
    s_mov_b32 s69, 256
    s_bitset1_b32 s69, s3
    s_bitset1_b32 s69, s90
    s_or_b32 s1, s69, 16
    s_getreg_b32 s0, hwreg(HW_REG_XCC_ID, 0, 4)
    s_add_u32 s0, s0, 1
    s_lshl_b32 s0, s0, 8
    s_mov_b32 s62, 1
    s_mov_b32 s72, 24576
    s_mov_b32 s63, 0
    s_mov_b32 s68, 12288
    s_cmp_lg_u32 s2, 0
    s_cbranch_scc1 L_nc
    s_lshl_b32 s70, s52, 13
    buffer_store_dwordx4 v[0:3], v248, s[12:15], s70 offen sc1
    s_add_u32 s70, s70, 1024
    buffer_store_dwordx4 v[0:3], v248, s[12:15], s70 offen sc1
    s_add_u32 s70, s70, 1024
    buffer_store_dwordx4 v[0:3], v248, s[12:15], s70 offen sc1
    s_add_u32 s70, s70, 1024
    buffer_store_dwordx4 v[0:3], v248, s[12:15], s70 offen sc1
    s_add_u32 s70, s70, 1024
    buffer_store_dwordx4 v[0:3], v248, s[12:15], s70 offen sc1
    s_add_u32 s70, s70, 1024
    buffer_store_dwordx4 v[0:3], v248, s[12:15], s70 offen sc1
    s_add_u32 s70, s70, 1024
    buffer_store_dwordx4 v[0:3], v248, s[12:15], s70 offen sc1
    s_add_u32 s70, s70, 1024
    buffer_store_dwordx4 v[0:3], v248, s[12:15], s70 offen sc1
    s_add_u32 s70, s70, 1024
L_nc:
    s_add_u32 m0, s60, 3072
    s_add_u32 s73, s57, 196608
    buffer_load_dwordx4 v209, s[32:35], s73 offen offset:0  lds
    buffer_load_dwordx4 v210, s[32:35], s73 offen offset:1024  lds
    buffer_load_dwordx4 v211, s[32:35], s73 offen offset:2048  lds
    s_add_u32 s60, s60, 24576
    s_cmp_ge_u32 s60, 73728
    s_cselect_b32 s60, s74, s60
    s_lshr_b64 s[98:99], s[98:99], 4
    s_and_b32 s59, s98, 15
    s_lshl_b32 s59, s59, 7
    s_mul_i32 s57, s59, 6144
    s_add_u32 s57, s57, s97
    s_mov_b32 m0, s61
    s_nop 0
    buffer_load_dwordx4 v212, s[28:31], s59 offen offset:0 lds
    buffer_load_dwordx4 v213, s[28:31], s59 offen offset:1024 lds
    buffer_load_dwordx4 v214, s[28:31], s59 offen offset:2048 lds
    s_waitcnt vmcnt(9)
    s_barrier
    ds_read_b128 a[168:171], v227 offset:0
    s_mov_b32 m0, s60
    s_nop 0
    buffer_load_dwordx4 v209, s[32:35], s57 offen offset:0  lds
    ds_read_b128 a[172:175], v227 offset:2048
    ds_read_b128 a[176:179], v227 offset:4096
    ds_read_b64_tr_b16 a[72:73], v223 offset:0
    buffer_load_dwordx4 v210, s[32:35], s57 offen offset:1024  lds
    ds_read_b64_tr_b16 a[74:75], v223 offset:6144
    ds_read_b64_tr_b16 a[76:77], v224 offset:0
    ds_read_b64_tr_b16 a[78:79], v224 offset:6144
    buffer_load_dwordx4 v211, s[32:35], s57 offen offset:2048  lds
    ds_read_b64_tr_b16 a[80:81], v225 offset:0
    ds_read_b64_tr_b16 a[82:83], v225 offset:6144
    ds_read_b64_tr_b16 a[84:85], v226 offset:0
    s_add_u32 m0, s60, 3072
    s_add_u32 s73, s57, 196608
    buffer_load_dwordx4 v209, s[32:35], s73 offen offset:0  lds
    ds_read_b64_tr_b16 a[86:87], v226 offset:6144
    ds_read_b64_tr_b16 a[88:89], v223 offset:128
    ds_read_b64_tr_b16 a[90:91], v223 offset:6272
    buffer_load_dwordx4 v210, s[32:35], s73 offen offset:1024  lds
    ds_read_b64_tr_b16 a[92:93], v224 offset:128
    ds_read_b64_tr_b16 a[94:95], v224 offset:6272
    ds_read_b64_tr_b16 a[96:97], v225 offset:128
    buffer_load_dwordx4 v211, s[32:35], s73 offen offset:2048  lds
    ds_read_b64_tr_b16 a[98:99], v225 offset:6272
    ds_read_b64_tr_b16 a[100:101], v226 offset:128
    ds_read_b64_tr_b16 a[102:103], v226 offset:6272
    s_add_u32 s60, s60, 24576
    s_cmp_ge_u32 s60, 73728
    s_cselect_b32 s60, s74, s60
    ds_read_b64_tr_b16 a[104:105], v223 offset:256
    ds_read_b64_tr_b16 a[106:107], v223 offset:6400
    ds_read_b64_tr_b16 a[108:109], v224 offset:256
    s_mul_i32 s57, s59, 6144
    s_add_u32 s57, s57, s58
    ds_read_b64_tr_b16 a[110:111], v224 offset:6400
    ds_read_b64_tr_b16 a[112:113], v225 offset:256
    ds_read_b64_tr_b16 a[114:115], v225 offset:6400
    s_xor_b32 s61, s61, s75
    ds_read_b64_tr_b16 a[116:117], v226 offset:256
    ds_read_b64_tr_b16 a[118:119], v226 offset:6400
    s_add_u32 s62, s62, 1
    s_cmp_ge_u32 s62, 3
    s_cselect_b32 s62, 0, s62
    s_cselect_b32 s71, 4294918144, s72
    v_add_u32 v223, s71, v223
    v_add_u32 v224, s71, v224
    v_add_u32 v225, s71, v225
    v_add_u32 v226, s71, v226
    v_add_u32 v227, s68, v227
    s_waitcnt lgkmcnt(0)
L_q:
    s_bitcmp1_b32 s69, s63
    s_waitcnt vmcnt(15) lgkmcnt(0)
    s_cbranch_scc1 L_qwe
    s_waitcnt vmcnt(9)
L_qwe:
    s_barrier
    v_mfma_f32_16x16x32_bf16 v[0:3], a[72:75], a[168:171], v[0:3]
    s_mov_b32 m0, s60
    s_nop 0
    buffer_load_dwordx4 v209, s[32:35], s57 offen offset:0  lds
    v_mfma_f32_16x16x32_bf16 v[4:7], a[72:75], a[172:175], v[4:7]
    ds_read_b128 a[180:183], v228 offset:0
    ds_read_b128 a[184:187], v228 offset:2048
    v_mfma_f32_16x16x32_bf16 v[8:11], a[72:75], a[176:179], v[8:11]
    ds_read_b128 a[188:191], v228 offset:4096
    v_mfma_f32_16x16x32_bf16 v[20:23], a[76:79], a[176:179], v[20:23]
    ds_read_b64_tr_b16 a[120:121], v223 offset:0
    v_mfma_f32_16x16x32_bf16 v[16:19], a[76:79], a[172:175], v[16:19]
    ds_read_b64_tr_b16 a[122:123], v223 offset:6144
    v_mfma_f32_16x16x32_bf16 v[12:15], a[76:79], a[168:171], v[12:15]
    buffer_load_dwordx4 v210, s[32:35], s57 offen offset:1024  lds
    v_mfma_f32_16x16x32_bf16 v[24:27], a[80:83], a[168:171], v[24:27]
    ds_read_b64_tr_b16 a[124:125], v224 offset:0
    v_mfma_f32_16x16x32_bf16 v[28:31], a[80:83], a[172:175], v[28:31]
    ds_read_b64_tr_b16 a[126:127], v224 offset:6144
    v_mfma_f32_16x16x32_bf16 v[32:35], a[80:83], a[176:179], v[32:35]
    ds_read_b64_tr_b16 a[128:129], v225 offset:0
    v_mfma_f32_16x16x32_bf16 v[44:47], a[84:87], a[176:179], v[44:47]
    ds_read_b64_tr_b16 a[130:131], v225 offset:6144
    v_add_u32 v228, s68, v228
    v_mfma_f32_16x16x32_bf16 v[40:43], a[84:87], a[172:175], v[40:43]
    buffer_load_dwordx4 v211, s[32:35], s57 offen offset:2048  lds
    v_mfma_f32_16x16x32_bf16 v[36:39], a[84:87], a[168:171], v[36:39]
    ds_read_b64_tr_b16 a[132:133], v226 offset:0
    v_mfma_f32_16x16x32_bf16 v[48:51], a[88:91], a[168:171], v[48:51]
    ds_read_b64_tr_b16 a[134:135], v226 offset:6144
    v_mfma_f32_16x16x32_bf16 v[52:55], a[88:91], a[172:175], v[52:55]
    ds_read_b64_tr_b16 a[136:137], v223 offset:128
    v_mfma_f32_16x16x32_bf16 v[56:59], a[88:91], a[176:179], v[56:59]
    s_add_u32 m0, s60, 3072
    s_add_u32 s73, s57, 196608
    ds_read_b64_tr_b16 a[138:139], v223 offset:6272
    v_mfma_f32_16x16x32_bf16 v[68:71], a[92:95], a[176:179], v[68:71]
    buffer_load_dwordx4 v209, s[32:35], s73 offen offset:0  lds
    v_mfma_f32_16x16x32_bf16 v[64:67], a[92:95], a[172:175], v[64:67]
    ds_read_b64_tr_b16 a[140:141], v224 offset:128
    v_mfma_f32_16x16x32_bf16 v[60:63], a[92:95], a[168:171], v[60:63]
    ds_read_b64_tr_b16 a[142:143], v224 offset:6272
    s_add_u32 s62, s62, 1
    s_cmp_ge_u32 s62, 3
    v_mfma_f32_16x16x32_bf16 v[72:75], a[96:99], a[168:171], v[72:75]
    ds_read_b64_tr_b16 a[144:145], v225 offset:128
    s_cselect_b32 s62, 0, s62
    s_cselect_b32 s71, 4294918144, s72
    v_mfma_f32_16x16x32_bf16 v[76:79], a[96:99], a[172:175], v[76:79]
    ds_read_b64_tr_b16 a[146:147], v225 offset:6272
    v_mfma_f32_16x16x32_bf16 v[80:83], a[96:99], a[176:179], v[80:83]
    buffer_load_dwordx4 v210, s[32:35], s73 offen offset:1024  lds
    v_mfma_f32_16x16x32_bf16 v[92:95], a[100:103], a[176:179], v[92:95]
    ds_read_b64_tr_b16 a[148:149], v226 offset:128
    v_mfma_f32_16x16x32_bf16 v[88:91], a[100:103], a[172:175], v[88:91]
    ds_read_b64_tr_b16 a[150:151], v226 offset:6272
    v_mfma_f32_16x16x32_bf16 v[84:87], a[100:103], a[168:171], v[84:87]
    ds_read_b64_tr_b16 a[152:153], v223 offset:256
    v_mfma_f32_16x16x32_bf16 v[96:99], a[104:107], a[168:171], v[96:99]
    ds_read_b64_tr_b16 a[154:155], v223 offset:6400
    v_mfma_f32_16x16x32_bf16 v[100:103], a[104:107], a[172:175], v[100:103]
    buffer_load_dwordx4 v211, s[32:35], s73 offen offset:2048  lds
    v_add_u32 v223, s71, v223
    v_mfma_f32_16x16x32_bf16 v[104:107], a[104:107], a[176:179], v[104:107]
    s_add_u32 s60, s60, 24576
    s_cmp_ge_u32 s60, 73728
    s_cselect_b32 s60, s74, s60
    ds_read_b64_tr_b16 a[156:157], v224 offset:256
    v_mfma_f32_16x16x32_bf16 v[116:119], a[108:111], a[176:179], v[116:119]
    s_lshr_b64 s[98:99], s[98:99], 4
    s_and_b32 s59, s98, 15
    s_lshl_b32 s59, s59, 7
    ds_read_b64_tr_b16 a[158:159], v224 offset:6400
    v_mfma_f32_16x16x32_bf16 v[112:115], a[108:111], a[172:175], v[112:115]
    ds_read_b64_tr_b16 a[160:161], v225 offset:256
    v_add_u32 v224, s71, v224
    v_mfma_f32_16x16x32_bf16 v[108:111], a[108:111], a[168:171], v[108:111]
    ds_read_b64_tr_b16 a[162:163], v225 offset:6400
    v_mfma_f32_16x16x32_bf16 v[120:123], a[112:115], a[168:171], v[120:123]
    ds_read_b64_tr_b16 a[164:165], v226 offset:256
    v_add_u32 v225, s71, v225
    v_mfma_f32_16x16x32_bf16 v[124:127], a[112:115], a[172:175], v[124:127]
    ds_read_b64_tr_b16 a[166:167], v226 offset:6400
    v_mfma_f32_16x16x32_bf16 v[128:131], a[112:115], a[176:179], v[128:131]
    v_add_u32 v226, s71, v226
    v_mfma_f32_16x16x32_bf16 v[140:143], a[116:119], a[176:179], v[140:143]
    s_mul_i32 s57, s59, 6144
    s_add_u32 s57, s57, s97
    v_mfma_f32_16x16x32_bf16 v[136:139], a[116:119], a[172:175], v[136:139]
    v_mfma_f32_16x16x32_bf16 v[132:135], a[116:119], a[168:171], v[132:135]
    s_bitcmp1_b32 s69, s63
    s_waitcnt vmcnt(12) lgkmcnt(0)
    s_cbranch_scc1 L_qwo
    s_waitcnt vmcnt(6)
L_qwo:
    s_barrier
    v_mfma_f32_16x16x32_bf16 v[0:3], a[120:123], a[180:183], v[0:3]
    s_mov_b32 m0, s61
    s_nop 0
    buffer_load_dwordx4 v212, s[28:31], s59 offen offset:0 lds
    v_mfma_f32_16x16x32_bf16 v[4:7], a[120:123], a[184:187], v[4:7]
    ds_read_b128 a[168:171], v227 offset:0
    ds_read_b128 a[172:175], v227 offset:2048
    v_mfma_f32_16x16x32_bf16 v[8:11], a[120:123], a[188:191], v[8:11]
    ds_read_b128 a[176:179], v227 offset:4096
    v_mfma_f32_16x16x32_bf16 v[20:23], a[124:127], a[188:191], v[20:23]
    ds_read_b64_tr_b16 a[72:73], v223 offset:0
    v_mfma_f32_16x16x32_bf16 v[16:19], a[124:127], a[184:187], v[16:19]
    buffer_load_dwordx4 v213, s[28:31], s59 offen offset:1024 lds
    v_mfma_f32_16x16x32_bf16 v[12:15], a[124:127], a[180:183], v[12:15]
    ds_read_b64_tr_b16 a[74:75], v223 offset:6144
    v_mfma_f32_16x16x32_bf16 v[24:27], a[128:131], a[180:183], v[24:27]
    ds_read_b64_tr_b16 a[76:77], v224 offset:0
    v_mfma_f32_16x16x32_bf16 v[28:31], a[128:131], a[184:187], v[28:31]
    ds_read_b64_tr_b16 a[78:79], v224 offset:6144
    v_mfma_f32_16x16x32_bf16 v[32:35], a[128:131], a[188:191], v[32:35]
    buffer_load_dwordx4 v214, s[28:31], s59 offen offset:2048 lds
    v_mfma_f32_16x16x32_bf16 v[44:47], a[132:135], a[188:191], v[44:47]
    ds_read_b64_tr_b16 a[80:81], v225 offset:0
    s_sub_u32 s68, 0, s68
    v_add_u32 v227, s68, v227
    v_mfma_f32_16x16x32_bf16 v[40:43], a[132:135], a[184:187], v[40:43]
    ds_read_b64_tr_b16 a[82:83], v225 offset:6144
    v_mfma_f32_16x16x32_bf16 v[36:39], a[132:135], a[180:183], v[36:39]
    s_mov_b32 m0, s60
    ds_read_b64_tr_b16 a[84:85], v226 offset:0
    ds_read_b64_tr_b16 a[86:87], v226 offset:6144
    v_mfma_f32_16x16x32_bf16 v[48:51], a[136:139], a[180:183], v[48:51]
    buffer_load_dwordx4 v209, s[32:35], s57 offen offset:0  lds
    v_mfma_f32_16x16x32_bf16 v[52:55], a[136:139], a[184:187], v[52:55]
    s_xor_b32 s61, s61, s75
    ds_read_b64_tr_b16 a[88:89], v223 offset:128
    v_mfma_f32_16x16x32_bf16 v[56:59], a[136:139], a[188:191], v[56:59]
    ds_read_b64_tr_b16 a[90:91], v223 offset:6272
    v_mfma_f32_16x16x32_bf16 v[68:71], a[140:143], a[188:191], v[68:71]
    ds_read_b64_tr_b16 a[92:93], v224 offset:128
    v_mfma_f32_16x16x32_bf16 v[64:67], a[140:143], a[184:187], v[64:67]
    buffer_load_dwordx4 v210, s[32:35], s57 offen offset:1024  lds
    v_mfma_f32_16x16x32_bf16 v[60:63], a[140:143], a[180:183], v[60:63]
    ds_read_b64_tr_b16 a[94:95], v224 offset:6272
    s_add_u32 s62, s62, 1
    s_cmp_ge_u32 s62, 3
    v_mfma_f32_16x16x32_bf16 v[72:75], a[144:147], a[180:183], v[72:75]
    ds_read_b64_tr_b16 a[96:97], v225 offset:128
    s_cselect_b32 s62, 0, s62
    s_cselect_b32 s71, 4294918144, s72
    v_mfma_f32_16x16x32_bf16 v[76:79], a[144:147], a[184:187], v[76:79]
    ds_read_b64_tr_b16 a[98:99], v225 offset:6272
    v_mfma_f32_16x16x32_bf16 v[80:83], a[144:147], a[188:191], v[80:83]
    buffer_load_dwordx4 v211, s[32:35], s57 offen offset:2048  lds
    v_mfma_f32_16x16x32_bf16 v[92:95], a[148:151], a[188:191], v[92:95]
    ds_read_b64_tr_b16 a[100:101], v226 offset:128
    v_mfma_f32_16x16x32_bf16 v[88:91], a[148:151], a[184:187], v[88:91]
    ds_read_b64_tr_b16 a[102:103], v226 offset:6272
    ds_read_b64_tr_b16 a[104:105], v223 offset:256
    v_mfma_f32_16x16x32_bf16 v[84:87], a[148:151], a[180:183], v[84:87]
    s_add_u32 m0, s60, 3072
    s_add_u32 s73, s57, 196608
    ds_read_b64_tr_b16 a[106:107], v223 offset:6400
    v_mfma_f32_16x16x32_bf16 v[96:99], a[152:155], a[180:183], v[96:99]
    buffer_load_dwordx4 v209, s[32:35], s73 offen offset:0  lds
    v_add_u32 v223, s71, v223
    v_mfma_f32_16x16x32_bf16 v[100:103], a[152:155], a[184:187], v[100:103]
    ds_read_b64_tr_b16 a[108:109], v224 offset:256
    v_mfma_f32_16x16x32_bf16 v[104:107], a[152:155], a[188:191], v[104:107]
    ds_read_b64_tr_b16 a[110:111], v224 offset:6400
    v_mfma_f32_16x16x32_bf16 v[116:119], a[156:159], a[188:191], v[116:119]
    ds_read_b64_tr_b16 a[112:113], v225 offset:256
    v_add_u32 v224, s71, v224
    v_mfma_f32_16x16x32_bf16 v[112:115], a[156:159], a[184:187], v[112:115]
    buffer_load_dwordx4 v210, s[32:35], s73 offen offset:1024  lds
    v_mfma_f32_16x16x32_bf16 v[108:111], a[156:159], a[180:183], v[108:111]
    s_add_u32 s60, s60, 24576
    s_cmp_ge_u32 s60, 73728
    s_cselect_b32 s60, s74, s60
    ds_read_b64_tr_b16 a[114:115], v225 offset:6400
    v_mfma_f32_16x16x32_bf16 v[120:123], a[160:163], a[180:183], v[120:123]
    ds_read_b64_tr_b16 a[116:117], v226 offset:256
    v_add_u32 v225, s71, v225
    v_mfma_f32_16x16x32_bf16 v[124:127], a[160:163], a[184:187], v[124:127]
    ds_read_b64_tr_b16 a[118:119], v226 offset:6400
    v_mfma_f32_16x16x32_bf16 v[128:131], a[160:163], a[188:191], v[128:131]
    buffer_load_dwordx4 v211, s[32:35], s73 offen offset:2048  lds
    v_add_u32 v226, s71, v226
    v_mfma_f32_16x16x32_bf16 v[140:143], a[164:167], a[188:191], v[140:143]
    s_mul_i32 s57, s59, 6144
    s_add_u32 s57, s57, s58
    v_mfma_f32_16x16x32_bf16 v[136:139], a[164:167], a[184:187], v[136:139]
    s_add_u32 s63, s63, 1
    s_bitcmp0_b32 s1, s63
    v_mfma_f32_16x16x32_bf16 v[132:135], a[164:167], a[180:183], v[132:135]
    s_waitcnt lgkmcnt(0)
    s_cbranch_scc1 L_q
    s_cmp_lg_u32 s63, s3
    s_cbranch_scc1 L_q1
    s_or_b32 s70, s2, s52
    s_cbranch_scc1 L_na
    v_mov_b32 v242, 1
    buffer_store_dword v242, v243, s[16:19], 0 offen sc1
L_na:
    s_mov_b32 m0, s66
    s_nop 0
    buffer_load_dwordx4 v200, s[36:39], s64 offen offset:0 nt lds
    buffer_load_dwordx4 v201, s[36:39], s64 offen offset:1024 nt lds
    buffer_load_dwordx4 v202, s[36:39], s64 offen offset:2048 nt lds
    s_add_u32 m0, s66, 3072
    s_nop 0
    buffer_load_dwordx4 v203, s[36:39], s64 offen offset:0 nt lds
    buffer_load_dwordx4 v204, s[36:39], s64 offen offset:1024 nt lds
    buffer_load_dwordx4 v205, s[36:39], s64 offen offset:2048 nt lds
    s_add_u32 s64, s64, 12288
    s_add_u32 s66, s66, 49152
    s_cmp_ge_u32 s66, 147456
    s_cselect_b32 s70, 147456, 0
    s_sub_u32 s66, s66, s70
L_q1:
    s_cmp_lg_u32 s63, 4
    s_cbranch_scc1 L_q3
    buffer_load_dword v244, off, s[16:19], 0 sc1
L_q3:
    s_cmp_lg_u32 s63, s90
    s_cbranch_scc1 L_q2
    s_mov_b32 s73, 0
L_c0:
    v_readfirstlane_b32 s70, v244
    s_nop 0
    s_cmp_eq_u32 s70, 1
    s_cbranch_scc0 L_s0
L_k0:
    s_add_u32 s71, s0, 0
    v_mov_b32 v242, s71
    buffer_store_dword v242, v243, s[4:7], 0 offen sc1
    s_mov_b32 m0, s67
    s_nop 0
    buffer_load_dwordx4 v206, s[40:43], s65 offen offset:0 nt lds
    buffer_load_dwordx4 v207, s[40:43], s65 offen offset:1024 nt lds
    buffer_load_dwordx4 v208, s[40:43], s65 offen offset:2048 nt lds
    s_add_u32 m0, s67, 3072
    s_add_u32 s73, s65, 3072
    buffer_load_dwordx4 v206, s[40:43], s73 offen offset:0 nt lds
    buffer_load_dwordx4 v207, s[40:43], s73 offen offset:1024 nt lds
    buffer_load_dwordx4 v208, s[40:43], s73 offen offset:2048 nt lds
    s_add_u32 s65, s65, 12288
    s_add_u32 s67, s67, 49152
    s_cmp_ge_u32 s67, 147456
    s_cselect_b32 s70, 147456, 0
    s_sub_u32 s67, s67, s70
L_q2:
    s_cmp_lt_u32 s63, 8
    s_cbranch_scc1 L_q
    s_waitcnt vmcnt(9) lgkmcnt(0)
    s_barrier
    v_mfma_f32_16x16x32_bf16 v[0:3], a[72:75], a[168:171], v[0:3]
    s_mov_b32 m0, s60
    s_nop 0
    buffer_load_dwordx4 v209, s[32:35], s57 offen offset:0  lds
    v_mfma_f32_16x16x32_bf16 v[4:7], a[72:75], a[172:175], v[4:7]
    ds_read_b128 a[180:183], v228 offset:0
    ds_read_b128 a[184:187], v228 offset:2048
    v_mfma_f32_16x16x32_bf16 v[8:11], a[72:75], a[176:179], v[8:11]
    ds_read_b128 a[188:191], v228 offset:4096
    v_mfma_f32_16x16x32_bf16 v[20:23], a[76:79], a[176:179], v[20:23]
    ds_read_b64_tr_b16 a[120:121], v223 offset:0
    v_mfma_f32_16x16x32_bf16 v[16:19], a[76:79], a[172:175], v[16:19]
    ds_read_b64_tr_b16 a[122:123], v223 offset:6144
    v_mfma_f32_16x16x32_bf16 v[12:15], a[76:79], a[168:171], v[12:15]
    buffer_load_dwordx4 v210, s[32:35], s57 offen offset:1024  lds
    v_mfma_f32_16x16x32_bf16 v[24:27], a[80:83], a[168:171], v[24:27]
    ds_read_b64_tr_b16 a[124:125], v224 offset:0
    v_mfma_f32_16x16x32_bf16 v[28:31], a[80:83], a[172:175], v[28:31]
    ds_read_b64_tr_b16 a[126:127], v224 offset:6144
    v_mfma_f32_16x16x32_bf16 v[32:35], a[80:83], a[176:179], v[32:35]
    ds_read_b64_tr_b16 a[128:129], v225 offset:0
    v_mfma_f32_16x16x32_bf16 v[44:47], a[84:87], a[176:179], v[44:47]
    ds_read_b64_tr_b16 a[130:131], v225 offset:6144
    v_add_u32 v228, s68, v228
    v_mfma_f32_16x16x32_bf16 v[40:43], a[84:87], a[172:175], v[40:43]
    buffer_load_dwordx4 v211, s[32:35], s57 offen offset:2048  lds
    v_mfma_f32_16x16x32_bf16 v[36:39], a[84:87], a[168:171], v[36:39]
    ds_read_b64_tr_b16 a[132:133], v226 offset:0
    v_mfma_f32_16x16x32_bf16 v[48:51], a[88:91], a[168:171], v[48:51]
    ds_read_b64_tr_b16 a[134:135], v226 offset:6144
    v_mfma_f32_16x16x32_bf16 v[52:55], a[88:91], a[172:175], v[52:55]
    ds_read_b64_tr_b16 a[136:137], v223 offset:128
    v_mfma_f32_16x16x32_bf16 v[56:59], a[88:91], a[176:179], v[56:59]
    s_add_u32 m0, s60, 3072
    s_add_u32 s73, s57, 196608
    ds_read_b64_tr_b16 a[138:139], v223 offset:6272
    v_mfma_f32_16x16x32_bf16 v[68:71], a[92:95], a[176:179], v[68:71]
    buffer_load_dwordx4 v209, s[32:35], s73 offen offset:0  lds
    v_mfma_f32_16x16x32_bf16 v[64:67], a[92:95], a[172:175], v[64:67]
    ds_read_b64_tr_b16 a[140:141], v224 offset:128
    v_mfma_f32_16x16x32_bf16 v[60:63], a[92:95], a[168:171], v[60:63]
    ds_read_b64_tr_b16 a[142:143], v224 offset:6272
    s_add_u32 s62, s62, 1
    s_cmp_ge_u32 s62, 3
    v_mfma_f32_16x16x32_bf16 v[72:75], a[96:99], a[168:171], v[72:75]
    ds_read_b64_tr_b16 a[144:145], v225 offset:128
    s_cselect_b32 s62, 0, s62
    s_cselect_b32 s71, 4294918144, s72
    v_mfma_f32_16x16x32_bf16 v[76:79], a[96:99], a[172:175], v[76:79]
    ds_read_b64_tr_b16 a[146:147], v225 offset:6272
    v_mfma_f32_16x16x32_bf16 v[80:83], a[96:99], a[176:179], v[80:83]
    buffer_load_dwordx4 v210, s[32:35], s73 offen offset:1024  lds
    v_mfma_f32_16x16x32_bf16 v[92:95], a[100:103], a[176:179], v[92:95]
    ds_read_b64_tr_b16 a[148:149], v226 offset:128
    v_mfma_f32_16x16x32_bf16 v[88:91], a[100:103], a[172:175], v[88:91]
    ds_read_b64_tr_b16 a[150:151], v226 offset:6272
    v_mfma_f32_16x16x32_bf16 v[84:87], a[100:103], a[168:171], v[84:87]
    ds_read_b64_tr_b16 a[152:153], v223 offset:256
    v_mfma_f32_16x16x32_bf16 v[96:99], a[104:107], a[168:171], v[96:99]
    ds_read_b64_tr_b16 a[154:155], v223 offset:6400
    v_mfma_f32_16x16x32_bf16 v[100:103], a[104:107], a[172:175], v[100:103]
    buffer_load_dwordx4 v211, s[32:35], s73 offen offset:2048  lds
    v_add_u32 v223, s71, v223
    v_mfma_f32_16x16x32_bf16 v[104:107], a[104:107], a[176:179], v[104:107]
    ds_read_b64_tr_b16 a[156:157], v224 offset:256
    v_mfma_f32_16x16x32_bf16 v[116:119], a[108:111], a[176:179], v[116:119]
    ds_read_b64_tr_b16 a[158:159], v224 offset:6400
    v_mfma_f32_16x16x32_bf16 v[112:115], a[108:111], a[172:175], v[112:115]
    ds_read_b64_tr_b16 a[160:161], v225 offset:256
    v_add_u32 v224, s71, v224
    v_mfma_f32_16x16x32_bf16 v[108:111], a[108:111], a[168:171], v[108:111]
    ds_read_b64_tr_b16 a[162:163], v225 offset:6400
    v_mfma_f32_16x16x32_bf16 v[120:123], a[112:115], a[168:171], v[120:123]
    ds_read_b64_tr_b16 a[164:165], v226 offset:256
    v_add_u32 v225, s71, v225
    v_mfma_f32_16x16x32_bf16 v[124:127], a[112:115], a[172:175], v[124:127]
    ds_read_b64_tr_b16 a[166:167], v226 offset:6400
    v_mfma_f32_16x16x32_bf16 v[128:131], a[112:115], a[176:179], v[128:131]
    v_add_u32 v226, s71, v226
    v_mfma_f32_16x16x32_bf16 v[140:143], a[116:119], a[176:179], v[140:143]
    v_mfma_f32_16x16x32_bf16 v[136:139], a[116:119], a[172:175], v[136:139]
    v_mfma_f32_16x16x32_bf16 v[132:135], a[116:119], a[168:171], v[132:135]
    s_waitcnt vmcnt(6) lgkmcnt(0)
    s_barrier
    v_mfma_f32_16x16x32_bf16 v[0:3], a[120:123], a[180:183], v[0:3]
    s_mov_b32 m0, s66
    s_nop 0
    buffer_load_dwordx4 v200, s[36:39], s64 offen offset:0 nt lds
    v_mfma_f32_16x16x32_bf16 v[4:7], a[120:123], a[184:187], v[4:7]
    ds_read_b128 a[168:171], v227 offset:0
    ds_read_b128 a[172:175], v227 offset:2048
    v_mfma_f32_16x16x32_bf16 v[8:11], a[120:123], a[188:191], v[8:11]
    ds_read_b128 a[176:179], v227 offset:4096
    v_mfma_f32_16x16x32_bf16 v[20:23], a[124:127], a[188:191], v[20:23]
    ds_read_b64_tr_b16 a[72:73], v223 offset:0
    v_mfma_f32_16x16x32_bf16 v[16:19], a[124:127], a[184:187], v[16:19]
    ds_read_b64_tr_b16 a[74:75], v223 offset:6144
    v_mfma_f32_16x16x32_bf16 v[12:15], a[124:127], a[180:183], v[12:15]
    buffer_load_dwordx4 v201, s[36:39], s64 offen offset:1024 nt lds
    v_mfma_f32_16x16x32_bf16 v[24:27], a[128:131], a[180:183], v[24:27]
    ds_read_b64_tr_b16 a[76:77], v224 offset:0
    v_mfma_f32_16x16x32_bf16 v[28:31], a[128:131], a[184:187], v[28:31]
    ds_read_b64_tr_b16 a[78:79], v224 offset:6144
    v_mfma_f32_16x16x32_bf16 v[32:35], a[128:131], a[188:191], v[32:35]
    ds_read_b64_tr_b16 a[80:81], v225 offset:0
    v_mfma_f32_16x16x32_bf16 v[44:47], a[132:135], a[188:191], v[44:47]
    ds_read_b64_tr_b16 a[82:83], v225 offset:6144
    s_sub_u32 s68, 0, s68
    v_add_u32 v227, s68, v227
    v_mfma_f32_16x16x32_bf16 v[40:43], a[132:135], a[184:187], v[40:43]
    buffer_load_dwordx4 v202, s[36:39], s64 offen offset:2048 nt lds
    v_mfma_f32_16x16x32_bf16 v[36:39], a[132:135], a[180:183], v[36:39]
    ds_read_b64_tr_b16 a[84:85], v226 offset:0
    v_mfma_f32_16x16x32_bf16 v[48:51], a[136:139], a[180:183], v[48:51]
    ds_read_b64_tr_b16 a[86:87], v226 offset:6144
    v_mfma_f32_16x16x32_bf16 v[52:55], a[136:139], a[184:187], v[52:55]
    ds_read_b64_tr_b16 a[88:89], v223 offset:128
    v_mfma_f32_16x16x32_bf16 v[56:59], a[136:139], a[188:191], v[56:59]
    s_add_u32 m0, s66, 3072
    ds_read_b64_tr_b16 a[90:91], v223 offset:6272
    v_mfma_f32_16x16x32_bf16 v[68:71], a[140:143], a[188:191], v[68:71]
    buffer_load_dwordx4 v203, s[36:39], s64 offen offset:0 nt lds
    v_mfma_f32_16x16x32_bf16 v[64:67], a[140:143], a[184:187], v[64:67]
    ds_read_b64_tr_b16 a[92:93], v224 offset:128
    v_mfma_f32_16x16x32_bf16 v[60:63], a[140:143], a[180:183], v[60:63]
    ds_read_b64_tr_b16 a[94:95], v224 offset:6272
    s_add_u32 s62, s62, 1
    s_cmp_ge_u32 s62, 3
    v_mfma_f32_16x16x32_bf16 v[72:75], a[144:147], a[180:183], v[72:75]
    ds_read_b64_tr_b16 a[96:97], v225 offset:128
    s_cselect_b32 s62, 0, s62
    s_cselect_b32 s71, 4294918144, s72
    v_mfma_f32_16x16x32_bf16 v[76:79], a[144:147], a[184:187], v[76:79]
    ds_read_b64_tr_b16 a[98:99], v225 offset:6272
    v_mfma_f32_16x16x32_bf16 v[80:83], a[144:147], a[188:191], v[80:83]
    buffer_load_dwordx4 v204, s[36:39], s64 offen offset:1024 nt lds
    v_mfma_f32_16x16x32_bf16 v[92:95], a[148:151], a[188:191], v[92:95]
    ds_read_b64_tr_b16 a[100:101], v226 offset:128
    v_mfma_f32_16x16x32_bf16 v[88:91], a[148:151], a[184:187], v[88:91]
    ds_read_b64_tr_b16 a[102:103], v226 offset:6272
    v_mfma_f32_16x16x32_bf16 v[84:87], a[148:151], a[180:183], v[84:87]
    ds_read_b64_tr_b16 a[104:105], v223 offset:256
    v_mfma_f32_16x16x32_bf16 v[96:99], a[152:155], a[180:183], v[96:99]
    ds_read_b64_tr_b16 a[106:107], v223 offset:6400
    v_mfma_f32_16x16x32_bf16 v[100:103], a[152:155], a[184:187], v[100:103]
    buffer_load_dwordx4 v205, s[36:39], s64 offen offset:2048 nt lds
    v_add_u32 v223, s71, v223
    v_mfma_f32_16x16x32_bf16 v[104:107], a[152:155], a[188:191], v[104:107]
    ds_read_b64_tr_b16 a[108:109], v224 offset:256
    v_mfma_f32_16x16x32_bf16 v[116:119], a[156:159], a[188:191], v[116:119]
    s_add_u32 s64, s64, 12288
    s_add_u32 s66, s66, 49152
    ds_read_b64_tr_b16 a[110:111], v224 offset:6400
    v_mfma_f32_16x16x32_bf16 v[112:115], a[156:159], a[184:187], v[112:115]
    ds_read_b64_tr_b16 a[112:113], v225 offset:256
    v_add_u32 v224, s71, v224
    v_mfma_f32_16x16x32_bf16 v[108:111], a[156:159], a[180:183], v[108:111]
    s_cmp_ge_u32 s66, 147456
    s_cselect_b32 s70, 147456, 0
    s_sub_u32 s66, s66, s70
    ds_read_b64_tr_b16 a[114:115], v225 offset:6400
    v_mfma_f32_16x16x32_bf16 v[120:123], a[160:163], a[180:183], v[120:123]
    ds_read_b64_tr_b16 a[116:117], v226 offset:256
    v_add_u32 v225, s71, v225
    v_mfma_f32_16x16x32_bf16 v[124:127], a[160:163], a[184:187], v[124:127]
    ds_read_b64_tr_b16 a[118:119], v226 offset:6400
    v_mfma_f32_16x16x32_bf16 v[128:131], a[160:163], a[188:191], v[128:131]
    v_add_u32 v226, s71, v226
    v_mfma_f32_16x16x32_bf16 v[140:143], a[164:167], a[188:191], v[140:143]
    v_mfma_f32_16x16x32_bf16 v[136:139], a[164:167], a[184:187], v[136:139]
    v_mfma_f32_16x16x32_bf16 v[132:135], a[164:167], a[180:183], v[132:135]
    s_waitcnt vmcnt(6) lgkmcnt(0)
    s_barrier
    v_mfma_f32_16x16x32_bf16 v[0:3], a[72:75], a[168:171], v[0:3]
    s_mov_b32 m0, s67
    s_nop 0
    buffer_load_dwordx4 v206, s[40:43], s65 offen offset:0 nt lds
    v_mfma_f32_16x16x32_bf16 v[4:7], a[72:75], a[172:175], v[4:7]
    ds_read_b128 a[180:183], v228 offset:0
    ds_read_b128 a[184:187], v228 offset:2048
    v_mfma_f32_16x16x32_bf16 v[8:11], a[72:75], a[176:179], v[8:11]
    ds_read_b128 a[188:191], v228 offset:4096
    v_mfma_f32_16x16x32_bf16 v[20:23], a[76:79], a[176:179], v[20:23]
    ds_read_b64_tr_b16 a[120:121], v223 offset:0
    v_mfma_f32_16x16x32_bf16 v[16:19], a[76:79], a[172:175], v[16:19]
    ds_read_b64_tr_b16 a[122:123], v223 offset:6144
    v_mfma_f32_16x16x32_bf16 v[12:15], a[76:79], a[168:171], v[12:15]
    buffer_load_dwordx4 v207, s[40:43], s65 offen offset:1024 nt lds
    v_mfma_f32_16x16x32_bf16 v[24:27], a[80:83], a[168:171], v[24:27]
    ds_read_b64_tr_b16 a[124:125], v224 offset:0
    v_mfma_f32_16x16x32_bf16 v[28:31], a[80:83], a[172:175], v[28:31]
    ds_read_b64_tr_b16 a[126:127], v224 offset:6144
    v_mfma_f32_16x16x32_bf16 v[32:35], a[80:83], a[176:179], v[32:35]
    ds_read_b64_tr_b16 a[128:129], v225 offset:0
    v_mfma_f32_16x16x32_bf16 v[44:47], a[84:87], a[176:179], v[44:47]
    ds_read_b64_tr_b16 a[130:131], v225 offset:6144
    v_add_u32 v228, s68, v228
    v_mfma_f32_16x16x32_bf16 v[40:43], a[84:87], a[172:175], v[40:43]
    buffer_load_dwordx4 v208, s[40:43], s65 offen offset:2048 nt lds
    v_mfma_f32_16x16x32_bf16 v[36:39], a[84:87], a[168:171], v[36:39]
    ds_read_b64_tr_b16 a[132:133], v226 offset:0
    v_mfma_f32_16x16x32_bf16 v[48:51], a[88:91], a[168:171], v[48:51]
    ds_read_b64_tr_b16 a[134:135], v226 offset:6144
    v_mfma_f32_16x16x32_bf16 v[52:55], a[88:91], a[172:175], v[52:55]
    ds_read_b64_tr_b16 a[136:137], v223 offset:128
    v_mfma_f32_16x16x32_bf16 v[56:59], a[88:91], a[176:179], v[56:59]
    s_add_u32 m0, s67, 3072
    s_add_u32 s73, s65, 3072
    ds_read_b64_tr_b16 a[138:139], v223 offset:6272
    v_mfma_f32_16x16x32_bf16 v[68:71], a[92:95], a[176:179], v[68:71]
    buffer_load_dwordx4 v206, s[40:43], s73 offen offset:0 nt lds
    v_mfma_f32_16x16x32_bf16 v[64:67], a[92:95], a[172:175], v[64:67]
    ds_read_b64_tr_b16 a[140:141], v224 offset:128
    v_mfma_f32_16x16x32_bf16 v[60:63], a[92:95], a[168:171], v[60:63]
    ds_read_b64_tr_b16 a[142:143], v224 offset:6272
    s_add_u32 s62, s62, 1
    s_cmp_ge_u32 s62, 3
    v_mfma_f32_16x16x32_bf16 v[72:75], a[96:99], a[168:171], v[72:75]
    ds_read_b64_tr_b16 a[144:145], v225 offset:128
    s_cselect_b32 s62, 0, s62
    s_cselect_b32 s71, 4294918144, s72
    v_mfma_f32_16x16x32_bf16 v[76:79], a[96:99], a[172:175], v[76:79]
    ds_read_b64_tr_b16 a[146:147], v225 offset:6272
    v_mfma_f32_16x16x32_bf16 v[80:83], a[96:99], a[176:179], v[80:83]
    buffer_load_dwordx4 v207, s[40:43], s73 offen offset:1024 nt lds
    v_mfma_f32_16x16x32_bf16 v[92:95], a[100:103], a[176:179], v[92:95]
    ds_read_b64_tr_b16 a[148:149], v226 offset:128
    v_mfma_f32_16x16x32_bf16 v[88:91], a[100:103], a[172:175], v[88:91]
    ds_read_b64_tr_b16 a[150:151], v226 offset:6272
    v_mfma_f32_16x16x32_bf16 v[84:87], a[100:103], a[168:171], v[84:87]
    ds_read_b64_tr_b16 a[152:153], v223 offset:256
    v_mfma_f32_16x16x32_bf16 v[96:99], a[104:107], a[168:171], v[96:99]
    ds_read_b64_tr_b16 a[154:155], v223 offset:6400
    v_mfma_f32_16x16x32_bf16 v[100:103], a[104:107], a[172:175], v[100:103]
    buffer_load_dwordx4 v208, s[40:43], s73 offen offset:2048 nt lds
    v_add_u32 v223, s71, v223
    v_mfma_f32_16x16x32_bf16 v[104:107], a[104:107], a[176:179], v[104:107]
    ds_read_b64_tr_b16 a[156:157], v224 offset:256
    v_mfma_f32_16x16x32_bf16 v[116:119], a[108:111], a[176:179], v[116:119]
    s_add_u32 s65, s65, 12288
    s_add_u32 s67, s67, 49152
    ds_read_b64_tr_b16 a[158:159], v224 offset:6400
    v_mfma_f32_16x16x32_bf16 v[112:115], a[108:111], a[172:175], v[112:115]
    ds_read_b64_tr_b16 a[160:161], v225 offset:256
    v_add_u32 v224, s71, v224
    v_mfma_f32_16x16x32_bf16 v[108:111], a[108:111], a[168:171], v[108:111]
    s_cmp_ge_u32 s67, 147456
    s_cselect_b32 s70, 147456, 0
    s_sub_u32 s67, s67, s70
    ds_read_b64_tr_b16 a[162:163], v225 offset:6400
    v_mfma_f32_16x16x32_bf16 v[120:123], a[112:115], a[168:171], v[120:123]
    ds_read_b64_tr_b16 a[164:165], v226 offset:256
    v_add_u32 v225, s71, v225
    v_mfma_f32_16x16x32_bf16 v[124:127], a[112:115], a[172:175], v[124:127]
    ds_read_b64_tr_b16 a[166:167], v226 offset:6400
    v_mfma_f32_16x16x32_bf16 v[128:131], a[112:115], a[176:179], v[128:131]
    v_add_u32 v226, s71, v226
    v_mfma_f32_16x16x32_bf16 v[140:143], a[116:119], a[176:179], v[140:143]
    v_mfma_f32_16x16x32_bf16 v[136:139], a[116:119], a[172:175], v[136:139]
    v_mfma_f32_16x16x32_bf16 v[132:135], a[116:119], a[168:171], v[132:135]
    s_waitcnt lgkmcnt(0)
    s_barrier
    v_mfma_f32_16x16x32_bf16 v[0:3], a[120:123], a[180:183], v[0:3]
    s_mov_b32 m0, s66
    s_nop 0
    buffer_load_dwordx4 v200, s[36:39], s64 offen offset:0 nt lds
    v_mfma_f32_16x16x32_bf16 v[4:7], a[120:123], a[184:187], v[4:7]
    v_mfma_f32_16x16x32_bf16 v[8:11], a[120:123], a[188:191], v[8:11]
    v_mfma_f32_16x16x32_bf16 v[20:23], a[124:127], a[188:191], v[20:23]
    v_mfma_f32_16x16x32_bf16 v[16:19], a[124:127], a[184:187], v[16:19]
    v_mfma_f32_16x16x32_bf16 v[12:15], a[124:127], a[180:183], v[12:15]
    buffer_load_dwordx4 v201, s[36:39], s64 offen offset:1024 nt lds
    v_mfma_f32_16x16x32_bf16 v[24:27], a[128:131], a[180:183], v[24:27]
    v_mfma_f32_16x16x32_bf16 v[28:31], a[128:131], a[184:187], v[28:31]
    v_mfma_f32_16x16x32_bf16 v[32:35], a[128:131], a[188:191], v[32:35]
    v_mfma_f32_16x16x32_bf16 v[44:47], a[132:135], a[188:191], v[44:47]
    v_mfma_f32_16x16x32_bf16 v[40:43], a[132:135], a[184:187], v[40:43]
    buffer_load_dwordx4 v202, s[36:39], s64 offen offset:2048 nt lds
    v_cvt_pk_bf16_f32 v144, v0, v1
    v_cvt_pk_bf16_f32 v145, v2, v3
    v_mfma_f32_16x16x32_bf16 v[36:39], a[132:135], a[180:183], v[36:39]
    v_cvt_pk_bf16_f32 v146, v12, v13
    v_cvt_pk_bf16_f32 v147, v14, v15
    v_mfma_f32_16x16x32_bf16 v[48:51], a[136:139], a[180:183], v[48:51]
    v_cvt_pk_bf16_f32 v148, v4, v5
    v_cvt_pk_bf16_f32 v149, v6, v7
    v_mfma_f32_16x16x32_bf16 v[52:55], a[136:139], a[184:187], v[52:55]
    v_cvt_pk_bf16_f32 v150, v16, v17
    v_cvt_pk_bf16_f32 v151, v18, v19
    v_mfma_f32_16x16x32_bf16 v[56:59], a[136:139], a[188:191], v[56:59]
    s_add_u32 m0, s66, 3072
    v_cvt_pk_bf16_f32 v152, v8, v9
    v_cvt_pk_bf16_f32 v153, v10, v11
    v_mfma_f32_16x16x32_bf16 v[68:71], a[140:143], a[188:191], v[68:71]
    buffer_load_dwordx4 v203, s[36:39], s64 offen offset:0 nt lds
    v_cvt_pk_bf16_f32 v154, v20, v21
    v_cvt_pk_bf16_f32 v155, v22, v23
    v_mfma_f32_16x16x32_bf16 v[64:67], a[140:143], a[184:187], v[64:67]
    v_permlane32_swap_b32 v144, v146
    v_mfma_f32_16x16x32_bf16 v[60:63], a[140:143], a[180:183], v[60:63]
    v_permlane32_swap_b32 v145, v147
    v_permlane32_swap_b32 v148, v150
    v_mfma_f32_16x16x32_bf16 v[72:75], a[144:147], a[180:183], v[72:75]
    v_permlane32_swap_b32 v149, v151
    v_permlane32_swap_b32 v152, v154
    v_mfma_f32_16x16x32_bf16 v[76:79], a[144:147], a[184:187], v[76:79]
    v_permlane32_swap_b32 v153, v155
    v_permlane16_swap_b32 v144, v146
    v_mfma_f32_16x16x32_bf16 v[80:83], a[144:147], a[188:191], v[80:83]
    buffer_load_dwordx4 v204, s[36:39], s64 offen offset:1024 nt lds
    v_permlane16_swap_b32 v145, v147
    v_permlane16_swap_b32 v148, v150
    v_mfma_f32_16x16x32_bf16 v[92:95], a[148:151], a[188:191], v[92:95]
    v_permlane16_swap_b32 v149, v151
    v_permlane16_swap_b32 v152, v154
    v_mfma_f32_16x16x32_bf16 v[88:91], a[148:151], a[184:187], v[88:91]
    v_permlane16_swap_b32 v153, v155
    v_mfma_f32_16x16x32_bf16 v[84:87], a[148:151], a[180:183], v[84:87]
    v_accvgpr_write_b32 a0, v144
    v_accvgpr_write_b32 a1, v145
    v_mfma_f32_16x16x32_bf16 v[96:99], a[152:155], a[180:183], v[96:99]
    v_accvgpr_write_b32 a2, v146
    v_accvgpr_write_b32 a3, v147
    v_mfma_f32_16x16x32_bf16 v[100:103], a[152:155], a[184:187], v[100:103]
    buffer_load_dwordx4 v205, s[36:39], s64 offen offset:2048 nt lds
    v_accvgpr_write_b32 a4, v148
    v_accvgpr_write_b32 a5, v149
    v_mfma_f32_16x16x32_bf16 v[104:107], a[152:155], a[188:191], v[104:107]
    v_accvgpr_write_b32 a6, v150
    v_accvgpr_write_b32 a7, v151
    v_mfma_f32_16x16x32_bf16 v[116:119], a[156:159], a[188:191], v[116:119]
    s_add_u32 s64, s64, 12288
    s_add_u32 s66, s66, 49152
    v_accvgpr_write_b32 a8, v152
    v_accvgpr_write_b32 a9, v153
    v_mfma_f32_16x16x32_bf16 v[112:115], a[156:159], a[184:187], v[112:115]
    v_accvgpr_write_b32 a10, v154
    v_accvgpr_write_b32 a11, v155
    v_mfma_f32_16x16x32_bf16 v[108:111], a[156:159], a[180:183], v[108:111]
    s_cmp_ge_u32 s66, 147456
    s_cselect_b32 s70, 147456, 0
    s_sub_u32 s66, s66, s70
    v_cvt_pk_bf16_f32 v156, v24, v25
    v_mfma_f32_16x16x32_bf16 v[120:123], a[160:163], a[180:183], v[120:123]
    v_cvt_pk_bf16_f32 v157, v26, v27
    v_cvt_pk_bf16_f32 v158, v36, v37
    v_mfma_f32_16x16x32_bf16 v[124:127], a[160:163], a[184:187], v[124:127]
    v_cvt_pk_bf16_f32 v159, v38, v39
    v_cvt_pk_bf16_f32 v160, v28, v29
    v_mfma_f32_16x16x32_bf16 v[128:131], a[160:163], a[188:191], v[128:131]
    v_cvt_pk_bf16_f32 v161, v30, v31
    v_cvt_pk_bf16_f32 v162, v40, v41
    v_mfma_f32_16x16x32_bf16 v[140:143], a[164:167], a[188:191], v[140:143]
    v_cvt_pk_bf16_f32 v163, v42, v43
    v_cvt_pk_bf16_f32 v164, v32, v33
    v_mfma_f32_16x16x32_bf16 v[136:139], a[164:167], a[184:187], v[136:139]
    v_cvt_pk_bf16_f32 v165, v34, v35
    v_cvt_pk_bf16_f32 v166, v44, v45
    v_mfma_f32_16x16x32_bf16 v[132:135], a[164:167], a[180:183], v[132:135]
    v_cvt_pk_bf16_f32 v167, v46, v47
    v_permlane32_swap_b32 v156, v158
    v_permlane32_swap_b32 v157, v159
    v_permlane32_swap_b32 v160, v162
    v_permlane32_swap_b32 v161, v163
    v_permlane32_swap_b32 v164, v166
    v_permlane32_swap_b32 v165, v167
    v_permlane16_swap_b32 v156, v158
    v_permlane16_swap_b32 v157, v159
    v_permlane16_swap_b32 v160, v162
    v_permlane16_swap_b32 v161, v163
    v_permlane16_swap_b32 v164, v166
    v_permlane16_swap_b32 v165, v167
    v_accvgpr_write_b32 a12, v156
    v_accvgpr_write_b32 a13, v157
    v_accvgpr_write_b32 a14, v158
    v_accvgpr_write_b32 a15, v159
    v_accvgpr_write_b32 a16, v160
    v_accvgpr_write_b32 a17, v161
    v_accvgpr_write_b32 a18, v162
    v_accvgpr_write_b32 a19, v163
    v_accvgpr_write_b32 a20, v164
    v_accvgpr_write_b32 a21, v165
    v_accvgpr_write_b32 a22, v166
    v_accvgpr_write_b32 a23, v167
    v_cvt_pk_bf16_f32 v144, v48, v49
    v_cvt_pk_bf16_f32 v145, v50, v51
    v_cvt_pk_bf16_f32 v146, v60, v61
    v_cvt_pk_bf16_f32 v147, v62, v63
    v_cvt_pk_bf16_f32 v148, v52, v53
    v_cvt_pk_bf16_f32 v149, v54, v55
    v_cvt_pk_bf16_f32 v150, v64, v65
    v_cvt_pk_bf16_f32 v151, v66, v67
    v_cvt_pk_bf16_f32 v152, v56, v57
    v_cvt_pk_bf16_f32 v153, v58, v59
    v_cvt_pk_bf16_f32 v154, v68, v69
    v_cvt_pk_bf16_f32 v155, v70, v71
    v_permlane32_swap_b32 v144, v146
    v_permlane32_swap_b32 v145, v147
    v_permlane32_swap_b32 v148, v150
    v_permlane32_swap_b32 v149, v151
    v_permlane32_swap_b32 v152, v154
    v_permlane32_swap_b32 v153, v155
    v_permlane16_swap_b32 v144, v146
    v_permlane16_swap_b32 v145, v147
    v_permlane16_swap_b32 v148, v150
    v_permlane16_swap_b32 v149, v151
    v_permlane16_swap_b32 v152, v154
    v_permlane16_swap_b32 v153, v155
    v_accvgpr_write_b32 a24, v144
    v_accvgpr_write_b32 a25, v145
    v_accvgpr_write_b32 a26, v146
    v_accvgpr_write_b32 a27, v147
    v_accvgpr_write_b32 a28, v148
    v_accvgpr_write_b32 a29, v149
    v_accvgpr_write_b32 a30, v150
    v_accvgpr_write_b32 a31, v151
    v_accvgpr_write_b32 a32, v152
    v_accvgpr_write_b32 a33, v153
    v_accvgpr_write_b32 a34, v154
    v_accvgpr_write_b32 a35, v155
    v_cvt_pk_bf16_f32 v156, v72, v73
    v_cvt_pk_bf16_f32 v157, v74, v75
    v_cvt_pk_bf16_f32 v158, v84, v85
    v_cvt_pk_bf16_f32 v159, v86, v87
    v_cvt_pk_bf16_f32 v160, v76, v77
    v_cvt_pk_bf16_f32 v161, v78, v79
    v_cvt_pk_bf16_f32 v162, v88, v89
    v_cvt_pk_bf16_f32 v163, v90, v91
    v_cvt_pk_bf16_f32 v164, v80, v81
    v_cvt_pk_bf16_f32 v165, v82, v83
    v_cvt_pk_bf16_f32 v166, v92, v93
    v_cvt_pk_bf16_f32 v167, v94, v95
    v_permlane32_swap_b32 v156, v158
    v_permlane32_swap_b32 v157, v159
    v_permlane32_swap_b32 v160, v162
    v_permlane32_swap_b32 v161, v163
    v_permlane32_swap_b32 v164, v166
    v_permlane32_swap_b32 v165, v167
    v_permlane16_swap_b32 v156, v158
    v_permlane16_swap_b32 v157, v159
    v_permlane16_swap_b32 v160, v162
    v_permlane16_swap_b32 v161, v163
    v_permlane16_swap_b32 v164, v166
    v_permlane16_swap_b32 v165, v167
    v_accvgpr_write_b32 a36, v156
    v_accvgpr_write_b32 a37, v157
    v_accvgpr_write_b32 a38, v158
    v_accvgpr_write_b32 a39, v159
    v_accvgpr_write_b32 a40, v160
    v_accvgpr_write_b32 a41, v161
    v_accvgpr_write_b32 a42, v162
    v_accvgpr_write_b32 a43, v163
    v_accvgpr_write_b32 a44, v164
    v_accvgpr_write_b32 a45, v165
    v_accvgpr_write_b32 a46, v166
    v_accvgpr_write_b32 a47, v167
    v_cvt_pk_bf16_f32 v144, v96, v97
    v_cvt_pk_bf16_f32 v145, v98, v99
    v_cvt_pk_bf16_f32 v146, v108, v109
    v_cvt_pk_bf16_f32 v147, v110, v111
    v_cvt_pk_bf16_f32 v148, v100, v101
    v_cvt_pk_bf16_f32 v149, v102, v103
    v_cvt_pk_bf16_f32 v150, v112, v113
    v_cvt_pk_bf16_f32 v151, v114, v115
    v_cvt_pk_bf16_f32 v152, v104, v105
    v_cvt_pk_bf16_f32 v153, v106, v107
    v_cvt_pk_bf16_f32 v154, v116, v117
    v_cvt_pk_bf16_f32 v155, v118, v119
    v_permlane32_swap_b32 v144, v146
    v_permlane32_swap_b32 v145, v147
    v_permlane32_swap_b32 v148, v150
    v_permlane32_swap_b32 v149, v151
    v_permlane32_swap_b32 v152, v154
    v_permlane32_swap_b32 v153, v155
    v_permlane16_swap_b32 v144, v146
    v_permlane16_swap_b32 v145, v147
    v_permlane16_swap_b32 v148, v150
    v_permlane16_swap_b32 v149, v151
    v_permlane16_swap_b32 v152, v154
    v_permlane16_swap_b32 v153, v155
    v_accvgpr_write_b32 a48, v144
    v_accvgpr_write_b32 a49, v145
    v_accvgpr_write_b32 a50, v146
    v_accvgpr_write_b32 a51, v147
    v_accvgpr_write_b32 a52, v148
    v_accvgpr_write_b32 a53, v149
    v_accvgpr_write_b32 a54, v150
    v_accvgpr_write_b32 a55, v151
    v_accvgpr_write_b32 a56, v152
    v_accvgpr_write_b32 a57, v153
    v_accvgpr_write_b32 a58, v154
    v_accvgpr_write_b32 a59, v155
    v_cvt_pk_bf16_f32 v156, v120, v121
    v_cvt_pk_bf16_f32 v157, v122, v123
    v_cvt_pk_bf16_f32 v158, v132, v133
    v_cvt_pk_bf16_f32 v159, v134, v135
    v_cvt_pk_bf16_f32 v160, v124, v125
    v_cvt_pk_bf16_f32 v161, v126, v127
    v_cvt_pk_bf16_f32 v162, v136, v137
    v_cvt_pk_bf16_f32 v163, v138, v139
    v_cvt_pk_bf16_f32 v164, v128, v129
    v_cvt_pk_bf16_f32 v165, v130, v131
    v_cvt_pk_bf16_f32 v166, v140, v141
    v_cvt_pk_bf16_f32 v167, v142, v143
    v_permlane32_swap_b32 v156, v158
    v_permlane32_swap_b32 v157, v159
    v_permlane32_swap_b32 v160, v162
    v_permlane32_swap_b32 v161, v163
    v_permlane32_swap_b32 v164, v166
    v_permlane32_swap_b32 v165, v167
    v_permlane16_swap_b32 v156, v158
    v_permlane16_swap_b32 v157, v159
    v_permlane16_swap_b32 v160, v162
    v_permlane16_swap_b32 v161, v163
    v_permlane16_swap_b32 v164, v166
    v_permlane16_swap_b32 v165, v167
    v_accvgpr_write_b32 a60, v156
    v_accvgpr_write_b32 a61, v157
    v_accvgpr_write_b32 a62, v158
    v_accvgpr_write_b32 a63, v159
    v_accvgpr_write_b32 a64, v160
    v_accvgpr_write_b32 a65, v161
    v_accvgpr_write_b32 a66, v162
    v_accvgpr_write_b32 a67, v163
    v_accvgpr_write_b32 a68, v164
    v_accvgpr_write_b32 a69, v165
    v_accvgpr_write_b32 a70, v166
    v_accvgpr_write_b32 a71, v167
    v_add_u32 v223, 122880, v223
    v_add_u32 v224, 122880, v224
    v_add_u32 v225, 122880, v225
    v_add_u32 v226, 122880, v226
    s_mov_b32 s62, 98304
    s_mov_b32 s63, 0
    s_mov_b32 s90, 0
    s_mov_b32 s72, 49152
    s_barrier
    ds_read_b128 a[72:75], v221 offset:0
    ds_read_b128 a[76:79], v221 offset:6144
    ds_read_b128 a[80:83], v222 offset:0
    ds_read_b128 a[84:87], v222 offset:6144
    ds_read_b128 a[88:91], v221 offset:128
    ds_read_b128 a[92:95], v221 offset:6272
    ds_read_b128 a[96:99], v222 offset:128
    s_waitcnt lgkmcnt(6)
    v_mfma_f32_16x16x32_bf16 v[144:147], a[72:75], a[0:3], 0
    ds_read_b128 a[100:103], v222 offset:6272
    s_waitcnt lgkmcnt(6)
    v_mfma_f32_16x16x32_bf16 v[156:159], a[76:79], a[0:3], 0
    ds_read_b128 a[104:107], v221 offset:256
    s_waitcnt lgkmcnt(6)
    v_mfma_f32_16x16x32_bf16 v[144:147], a[80:83], a[12:15], v[144:147]
    ds_read_b128 a[108:111], v221 offset:6400
    s_waitcnt lgkmcnt(6)
    v_mfma_f32_16x16x32_bf16 v[156:159], a[84:87], a[12:15], v[156:159]
    ds_read_b128 a[112:115], v222 offset:256
    s_waitcnt lgkmcnt(6)
    v_mfma_f32_16x16x32_bf16 v[144:147], a[88:91], a[24:27], v[144:147]
    ds_read_b128 a[116:119], v222 offset:6400
    s_waitcnt lgkmcnt(6)
    v_mfma_f32_16x16x32_bf16 v[156:159], a[92:95], a[24:27], v[156:159]
    s_add_u32 s62, s62, 49152
    s_cmp_ge_u32 s62, 147456
    s_waitcnt lgkmcnt(5)
    v_mfma_f32_16x16x32_bf16 v[144:147], a[96:99], a[36:39], v[144:147]
    s_cselect_b32 s62, 0, s62
    s_cselect_b32 s68, 4294868992, s72
    s_waitcnt lgkmcnt(4)
    v_mfma_f32_16x16x32_bf16 v[156:159], a[100:103], a[36:39], v[156:159]
    s_mov_b32 m0, s67
    s_waitcnt lgkmcnt(3)
    v_mfma_f32_16x16x32_bf16 v[144:147], a[104:107], a[48:51], v[144:147]
    v_add_u32 v221, s68, v221
    buffer_load_dwordx4 v206, s[40:43], s65 offen offset:0 nt lds
    s_waitcnt lgkmcnt(2)
    v_mfma_f32_16x16x32_bf16 v[156:159], a[108:111], a[48:51], v[156:159]
    v_add_u32 v222, s68, v222
    s_waitcnt lgkmcnt(1)
    v_mfma_f32_16x16x32_bf16 v[144:147], a[112:115], a[60:63], v[144:147]
    s_waitcnt lgkmcnt(0)
    v_mfma_f32_16x16x32_bf16 v[156:159], a[116:119], a[60:63], v[156:159]
    v_mfma_f32_16x16x32_bf16 v[148:151], a[72:75], a[4:7], 0
    v_mfma_f32_16x16x32_bf16 v[160:163], a[76:79], a[4:7], 0
    buffer_load_dwordx4 v207, s[40:43], s65 offen offset:1024 nt lds
    v_mfma_f32_16x16x32_bf16 v[148:151], a[80:83], a[16:19], v[148:151]
    v_mfma_f32_16x16x32_bf16 v[160:163], a[84:87], a[16:19], v[160:163]
    v_mfma_f32_16x16x32_bf16 v[148:151], a[88:91], a[28:31], v[148:151]
    v_mfma_f32_16x16x32_bf16 v[160:163], a[92:95], a[28:31], v[160:163]
    v_mfma_f32_16x16x32_bf16 v[148:151], a[96:99], a[40:43], v[148:151]
    buffer_load_dwordx4 v208, s[40:43], s65 offen offset:2048 nt lds
    v_mfma_f32_16x16x32_bf16 v[160:163], a[100:103], a[40:43], v[160:163]
    v_mfma_f32_16x16x32_bf16 v[148:151], a[104:107], a[52:55], v[148:151]
    v_mfma_f32_16x16x32_bf16 v[160:163], a[108:111], a[52:55], v[160:163]
    v_mfma_f32_16x16x32_bf16 v[148:151], a[112:115], a[64:67], v[148:151]
    s_add_u32 m0, s67, 3072
    s_add_u32 s73, s65, 3072
    v_mfma_f32_16x16x32_bf16 v[160:163], a[116:119], a[64:67], v[160:163]
    buffer_load_dwordx4 v206, s[40:43], s73 offen offset:0 nt lds
    v_mfma_f32_16x16x32_bf16 v[152:155], a[72:75], a[8:11], 0
    v_mfma_f32_16x16x32_bf16 v[164:167], a[76:79], a[8:11], 0
    v_mfma_f32_16x16x32_bf16 v[152:155], a[80:83], a[20:23], v[152:155]
    v_mfma_f32_16x16x32_bf16 v[164:167], a[84:87], a[20:23], v[164:167]
    v_mfma_f32_16x16x32_bf16 v[152:155], a[88:91], a[32:35], v[152:155]
    buffer_load_dwordx4 v207, s[40:43], s73 offen offset:1024 nt lds
    v_mfma_f32_16x16x32_bf16 v[164:167], a[92:95], a[32:35], v[164:167]
    v_mfma_f32_16x16x32_bf16 v[152:155], a[96:99], a[44:47], v[152:155]
    v_mfma_f32_16x16x32_bf16 v[164:167], a[100:103], a[44:47], v[164:167]
    v_mfma_f32_16x16x32_bf16 v[152:155], a[104:107], a[56:59], v[152:155]
    v_mfma_f32_16x16x32_bf16 v[164:167], a[108:111], a[56:59], v[164:167]
    buffer_load_dwordx4 v208, s[40:43], s73 offen offset:2048 nt lds
    v_mfma_f32_16x16x32_bf16 v[152:155], a[112:115], a[68:71], v[152:155]
    v_mfma_f32_16x16x32_bf16 v[164:167], a[116:119], a[68:71], v[164:167]
    s_add_u32 s65, s65, 12288
    s_add_u32 s67, s67, 49152
    s_cmp_ge_u32 s67, 147456
    s_cselect_b32 s70, 147456, 0
    s_sub_u32 s67, s67, s70
    s_branch L_slow
L_a:
    s_cmp_eq_u32 s63, 14
    s_cbranch_scc1 L_ae
    s_cmp_eq_u32 s63, s88
    s_cselect_b32 s90, 3, 0
    s_cbranch_scc1 L_sk
    s_barrier
    ds_read_b128 a[72:75], v221 offset:0
    ds_read_b128 a[76:79], v221 offset:6144
    ds_read_b128 a[80:83], v222 offset:0
    ds_read_b128 a[84:87], v222 offset:6144
    ds_read_b128 a[88:91], v221 offset:128
    ds_read_b128 a[92:95], v221 offset:6272
    ds_read_b128 a[96:99], v222 offset:128
    s_waitcnt lgkmcnt(6)
    v_mfma_f32_16x16x32_bf16 v[144:147], a[72:75], a[0:3], 0
    ds_read_b128 a[100:103], v222 offset:6272
    s_waitcnt lgkmcnt(6)
    v_mfma_f32_16x16x32_bf16 v[156:159], a[76:79], a[0:3], 0
    ds_read_b128 a[104:107], v221 offset:256
    s_waitcnt lgkmcnt(6)
    v_mfma_f32_16x16x32_bf16 v[144:147], a[80:83], a[12:15], v[144:147]
    ds_read_b128 a[108:111], v221 offset:6400
    s_waitcnt lgkmcnt(6)
    v_mfma_f32_16x16x32_bf16 v[156:159], a[84:87], a[12:15], v[156:159]
    ds_read_b128 a[112:115], v222 offset:256
    s_waitcnt lgkmcnt(6)
    v_mfma_f32_16x16x32_bf16 v[144:147], a[88:91], a[24:27], v[144:147]
    ds_read_b128 a[116:119], v222 offset:6400
    s_waitcnt lgkmcnt(6)
    v_mfma_f32_16x16x32_bf16 v[156:159], a[92:95], a[24:27], v[156:159]
    s_add_u32 s62, s62, 49152
    s_cmp_ge_u32 s62, 147456
    s_waitcnt lgkmcnt(5)
    v_mfma_f32_16x16x32_bf16 v[144:147], a[96:99], a[36:39], v[144:147]
    s_cselect_b32 s62, 0, s62
    s_cselect_b32 s68, 4294868992, s72
    s_waitcnt lgkmcnt(4)
    v_mfma_f32_16x16x32_bf16 v[156:159], a[100:103], a[36:39], v[156:159]
    s_mov_b32 m0, s67
    s_waitcnt vmcnt(5)
    s_waitcnt lgkmcnt(3)
    v_mfma_f32_16x16x32_bf16 v[144:147], a[104:107], a[48:51], v[144:147]
    v_add_u32 v221, s68, v221
    buffer_load_dwordx4 v206, s[40:43], s65 offen offset:0 nt lds
    s_waitcnt lgkmcnt(2)
    v_mfma_f32_16x16x32_bf16 v[156:159], a[108:111], a[48:51], v[156:159]
    v_add_u32 v222, s68, v222
    s_waitcnt lgkmcnt(1)
    v_mfma_f32_16x16x32_bf16 v[144:147], a[112:115], a[60:63], v[144:147]
    s_waitcnt lgkmcnt(0)
    v_mfma_f32_16x16x32_bf16 v[156:159], a[116:119], a[60:63], v[156:159]
    v_mfma_f32_16x16x32_bf16 v[148:151], a[72:75], a[4:7], 0
    v_mfma_f32_16x16x32_bf16 v[160:163], a[76:79], a[4:7], 0
    s_waitcnt vmcnt(5)
    v_mfma_f32_16x16x32_bf16 v[148:151], a[80:83], a[16:19], v[148:151]
    buffer_load_dwordx4 v207, s[40:43], s65 offen offset:1024 nt lds
    s_nop 0
    v_fma_f32 v209, v144, s56, -v187
    v_fma_f32 v210, v145, s56, -v187
    v_fma_f32 v211, v146, s56, -v187
    v_mfma_f32_16x16x32_bf16 v[160:163], a[84:87], a[16:19], v[160:163]
    v_fma_f32 v212, v147, s56, -v187
    v_fma_f32 v213, v156, s56, -v187
    v_fma_f32 v214, v157, s56, -v187
    v_mfma_f32_16x16x32_bf16 v[148:151], a[88:91], a[28:31], v[148:151]
    v_fma_f32 v227, v158, s56, -v187
    v_fma_f32 v228, v159, s56, -v187
    v_max3_f32 v192, v209, v210, v211
    v_mfma_f32_16x16x32_bf16 v[160:163], a[92:95], a[28:31], v[160:163]
    v_max3_f32 v192, v192, v212, v213
    v_max3_f32 v192, v192, v214, v227
    v_max_f32 v192, v192, v228
    v_mfma_f32_16x16x32_bf16 v[148:151], a[96:99], a[40:43], v[148:151]
    v_exp_f32 v209, v209
    v_exp_f32 v210, v210
    v_exp_f32 v211, v211
    v_mfma_f32_16x16x32_bf16 v[160:163], a[100:103], a[40:43], v[160:163]
    v_exp_f32 v212, v212
    v_exp_f32 v213, v213
    v_mfma_f32_16x16x32_bf16 v[148:151], a[104:107], a[52:55], v[148:151]
    v_exp_f32 v214, v214
    v_exp_f32 v227, v227
    v_exp_f32 v228, v228
    v_mfma_f32_16x16x32_bf16 v[160:163], a[108:111], a[52:55], v[160:163]
    s_waitcnt vmcnt(5)
    v_add_f32 v195, v209, v210
    v_add_f32 v193, v211, v212
    v_add_f32 v195, v195, v213
    v_mfma_f32_16x16x32_bf16 v[148:151], a[112:115], a[64:67], v[148:151]
    buffer_load_dwordx4 v208, s[40:43], s65 offen offset:2048 nt lds
    v_add_f32 v193, v193, v214
    v_add_f32 v195, v195, v227
    v_add_f32 v193, v193, v228
    v_mfma_f32_16x16x32_bf16 v[160:163], a[116:119], a[64:67], v[160:163]
    v_cvt_pk_bf16_f32 v168, v209, v210
    v_cvt_pk_bf16_f32 v169, v211, v212
    v_cvt_pk_bf16_f32 v170, v213, v214
    v_mfma_f32_16x16x32_bf16 v[152:155], a[72:75], a[8:11], 0
    v_cvt_pk_bf16_f32 v171, v227, v228
    v_add_f32 v195, v195, v193
    v_mfma_f32_16x16x32_bf16 v[164:167], a[76:79], a[8:11], 0
    v_mfma_f32_16x16x32_bf16 v[152:155], a[80:83], a[20:23], v[152:155]
    v_fma_f32 v209, v148, s56, -v189
    v_fma_f32 v210, v149, s56, -v189
    v_fma_f32 v211, v150, s56, -v189
    v_fma_f32 v212, v151, s56, -v189
    v_mfma_f32_16x16x32_bf16 v[164:167], a[84:87], a[20:23], v[164:167]
    v_fma_f32 v213, v160, s56, -v189
    v_fma_f32 v214, v161, s56, -v189
    v_fma_f32 v227, v162, s56, -v189
    v_mfma_f32_16x16x32_bf16 v[152:155], a[88:91], a[32:35], v[152:155]
    v_fma_f32 v228, v163, s56, -v189
    v_max3_f32 v192, v192, v209, v210
    v_max3_f32 v192, v192, v211, v212
    v_mfma_f32_16x16x32_bf16 v[164:167], a[92:95], a[32:35], v[164:167]
    s_add_u32 m0, s67, 3072
    s_add_u32 s73, s65, 3072
    s_waitcnt vmcnt(5)
    v_max3_f32 v192, v192, v213, v214
    v_max3_f32 v192, v192, v227, v228
    v_exp_f32 v209, v209
    v_mfma_f32_16x16x32_bf16 v[152:155], a[96:99], a[44:47], v[152:155]
    buffer_load_dwordx4 v206, s[40:43], s73 offen offset:0 nt lds
    v_exp_f32 v210, v210
    v_exp_f32 v211, v211
    v_exp_f32 v212, v212
    v_mfma_f32_16x16x32_bf16 v[164:167], a[100:103], a[44:47], v[164:167]
    v_exp_f32 v213, v213
    v_exp_f32 v214, v214
    v_exp_f32 v227, v227
    v_mfma_f32_16x16x32_bf16 v[152:155], a[104:107], a[56:59], v[152:155]
    v_exp_f32 v228, v228
    v_add_f32 v196, v209, v210
    v_add_f32 v193, v211, v212
    v_mfma_f32_16x16x32_bf16 v[164:167], a[108:111], a[56:59], v[164:167]
    v_add_f32 v196, v196, v213
    v_add_f32 v193, v193, v214
    v_add_f32 v196, v196, v227
    v_mfma_f32_16x16x32_bf16 v[152:155], a[112:115], a[68:71], v[152:155]
    v_add_f32 v193, v193, v228
    v_cvt_pk_bf16_f32 v172, v209, v210
    v_cvt_pk_bf16_f32 v173, v211, v212
    v_mfma_f32_16x16x32_bf16 v[164:167], a[116:119], a[68:71], v[164:167]
    v_cvt_pk_bf16_f32 v174, v213, v214
    v_cvt_pk_bf16_f32 v175, v227, v228
    v_add_f32 v196, v196, v193
    s_nop 0
    v_fma_f32 v209, v152, s56, -v191
    v_fma_f32 v210, v153, s56, -v191
    v_fma_f32 v211, v154, s56, -v191
    s_waitcnt vmcnt(5)
    buffer_load_dwordx4 v207, s[40:43], s73 offen offset:1024 nt lds
    v_fma_f32 v212, v155, s56, -v191
    v_fma_f32 v213, v164, s56, -v191
    v_fma_f32 v214, v165, s56, -v191
    v_fma_f32 v227, v166, s56, -v191
    v_fma_f32 v228, v167, s56, -v191
    v_max3_f32 v192, v192, v209, v210
    s_waitcnt vmcnt(5)
    buffer_load_dwordx4 v208, s[40:43], s73 offen offset:2048 nt lds
    v_max3_f32 v192, v192, v211, v212
    v_max3_f32 v192, v192, v213, v214
    v_max3_f32 v192, v192, v227, v228
    v_exp_f32 v209, v209
    v_exp_f32 v210, v210
    v_exp_f32 v211, v211
    s_add_u32 s65, s65, 12288
    s_add_u32 s67, s67, 49152
    v_exp_f32 v212, v212
    v_exp_f32 v213, v213
    v_exp_f32 v214, v214
    v_exp_f32 v227, v227
    v_exp_f32 v228, v228
    v_add_f32 v197, v209, v210
    s_cmp_ge_u32 s67, 147456
    s_cselect_b32 s70, 147456, 0
    s_sub_u32 s67, s67, s70
    v_add_f32 v193, v211, v212
    v_add_f32 v197, v197, v213
    v_add_f32 v193, v193, v214
    v_add_f32 v197, v197, v227
    v_add_f32 v193, v193, v228
    v_cvt_pk_bf16_f32 v176, v209, v210
    v_cvt_pk_bf16_f32 v177, v211, v212
    v_cvt_pk_bf16_f32 v178, v213, v214
    v_cvt_pk_bf16_f32 v179, v227, v228
    v_add_f32 v197, v197, v193
    v_cmp_lt_f32 vcc, s91, v192
    s_cbranch_vccnz L_slow
L_ret0:
    v_add_f32 v183, v183, v195
    v_add_f32 v184, v184, v196
    v_add_f32 v185, v185, v197
    s_barrier
    ds_read_b64_tr_b16 a[120:121], v223 offset:0
    ds_read_b64_tr_b16 a[122:123], v223 offset:6144
    ds_read_b64_tr_b16 a[124:125], v224 offset:0
    ds_read_b64_tr_b16 a[126:127], v224 offset:6144
    ds_read_b64_tr_b16 a[128:129], v225 offset:0
    ds_read_b64_tr_b16 a[130:131], v225 offset:6144
    s_waitcnt lgkmcnt(4)
    v_mfma_f32_16x16x32_bf16 v[0:3], a[120:123], v[168:171], v[0:3]
    ds_read_b64_tr_b16 a[132:133], v226 offset:0
    v_mfma_f32_16x16x32_bf16 v[4:7], a[120:123], v[172:175], v[4:7]
    ds_read_b64_tr_b16 a[134:135], v226 offset:6144
    v_mfma_f32_16x16x32_bf16 v[8:11], a[120:123], v[176:179], v[8:11]
    s_mov_b32 m0, s66
    s_waitcnt vmcnt(5)
    ds_read_b64_tr_b16 a[136:137], v223 offset:128
    s_waitcnt lgkmcnt(5)
    v_mfma_f32_16x16x32_bf16 v[12:15], a[124:127], v[168:171], v[12:15]
    buffer_load_dwordx4 v200, s[36:39], s64 offen offset:0 nt lds
    v_mfma_f32_16x16x32_bf16 v[16:19], a[124:127], v[172:175], v[16:19]
    ds_read_b64_tr_b16 a[138:139], v223 offset:6272
    v_mfma_f32_16x16x32_bf16 v[20:23], a[124:127], v[176:179], v[20:23]
    ds_read_b64_tr_b16 a[140:141], v224 offset:128
    s_waitcnt lgkmcnt(5)
    v_mfma_f32_16x16x32_bf16 v[24:27], a[128:131], v[168:171], v[24:27]
    ds_read_b64_tr_b16 a[142:143], v224 offset:6272
    v_mfma_f32_16x16x32_bf16 v[28:31], a[128:131], v[172:175], v[28:31]
    s_waitcnt vmcnt(5)
    ds_read_b64_tr_b16 a[144:145], v225 offset:128
    v_mfma_f32_16x16x32_bf16 v[32:35], a[128:131], v[176:179], v[32:35]
    buffer_load_dwordx4 v201, s[36:39], s64 offen offset:1024 nt lds
    s_waitcnt lgkmcnt(5)
    v_mfma_f32_16x16x32_bf16 v[36:39], a[132:135], v[168:171], v[36:39]
    ds_read_b64_tr_b16 a[146:147], v225 offset:6272
    v_mfma_f32_16x16x32_bf16 v[40:43], a[132:135], v[172:175], v[40:43]
    ds_read_b64_tr_b16 a[148:149], v226 offset:128
    v_mfma_f32_16x16x32_bf16 v[44:47], a[132:135], v[176:179], v[44:47]
    ds_read_b64_tr_b16 a[150:151], v226 offset:6272
    s_waitcnt lgkmcnt(6)
    v_mfma_f32_16x16x32_bf16 v[48:51], a[136:139], v[168:171], v[48:51]
    s_waitcnt vmcnt(5)
    ds_read_b64_tr_b16 a[152:153], v223 offset:256
    v_mfma_f32_16x16x32_bf16 v[52:55], a[136:139], v[172:175], v[52:55]
    buffer_load_dwordx4 v202, s[36:39], s64 offen offset:2048 nt lds
    v_mfma_f32_16x16x32_bf16 v[56:59], a[136:139], v[176:179], v[56:59]
    ds_read_b64_tr_b16 a[154:155], v223 offset:6400
    s_waitcnt lgkmcnt(6)
    v_mfma_f32_16x16x32_bf16 v[60:63], a[140:143], v[168:171], v[60:63]
    ds_read_b64_tr_b16 a[156:157], v224 offset:256
    v_mfma_f32_16x16x32_bf16 v[64:67], a[140:143], v[172:175], v[64:67]
    ds_read_b64_tr_b16 a[158:159], v224 offset:6400
    v_mfma_f32_16x16x32_bf16 v[68:71], a[140:143], v[176:179], v[68:71]
    s_add_u32 m0, s66, 3072
    s_waitcnt vmcnt(5)
    ds_read_b64_tr_b16 a[160:161], v225 offset:256
    s_waitcnt lgkmcnt(7)
    v_mfma_f32_16x16x32_bf16 v[72:75], a[144:147], v[168:171], v[72:75]
    buffer_load_dwordx4 v203, s[36:39], s64 offen offset:0 nt lds
    v_mfma_f32_16x16x32_bf16 v[76:79], a[144:147], v[172:175], v[76:79]
    ds_read_b64_tr_b16 a[162:163], v225 offset:6400
    v_mfma_f32_16x16x32_bf16 v[80:83], a[144:147], v[176:179], v[80:83]
    ds_read_b64_tr_b16 a[164:165], v226 offset:256
    s_waitcnt lgkmcnt(7)
    v_mfma_f32_16x16x32_bf16 v[84:87], a[148:151], v[168:171], v[84:87]
    ds_read_b64_tr_b16 a[166:167], v226 offset:6400
    v_mfma_f32_16x16x32_bf16 v[88:91], a[148:151], v[172:175], v[88:91]
    s_waitcnt vmcnt(5)
    v_mfma_f32_16x16x32_bf16 v[92:95], a[148:151], v[176:179], v[92:95]
    buffer_load_dwordx4 v204, s[36:39], s64 offen offset:1024 nt lds
    s_waitcnt lgkmcnt(6)
    v_mfma_f32_16x16x32_bf16 v[96:99], a[152:155], v[168:171], v[96:99]
    v_add_u32 v223, s68, v223
    v_mfma_f32_16x16x32_bf16 v[100:103], a[152:155], v[172:175], v[100:103]
    v_add_u32 v224, s68, v224
    v_mfma_f32_16x16x32_bf16 v[104:107], a[152:155], v[176:179], v[104:107]
    v_add_u32 v225, s68, v225
    s_waitcnt lgkmcnt(4)
    v_mfma_f32_16x16x32_bf16 v[108:111], a[156:159], v[168:171], v[108:111]
    s_waitcnt vmcnt(5)
    v_add_u32 v226, s68, v226
    v_mfma_f32_16x16x32_bf16 v[112:115], a[156:159], v[172:175], v[112:115]
    buffer_load_dwordx4 v205, s[36:39], s64 offen offset:2048 nt lds
    v_mfma_f32_16x16x32_bf16 v[116:119], a[156:159], v[176:179], v[116:119]
    s_waitcnt lgkmcnt(2)
    v_mfma_f32_16x16x32_bf16 v[120:123], a[160:163], v[168:171], v[120:123]
    s_add_u32 s64, s64, 12288
    s_add_u32 s66, s66, 49152
    v_mfma_f32_16x16x32_bf16 v[124:127], a[160:163], v[172:175], v[124:127]
    s_cmp_ge_u32 s66, 147456
    s_cselect_b32 s70, 147456, 0
    s_sub_u32 s66, s66, s70
    v_mfma_f32_16x16x32_bf16 v[128:131], a[160:163], v[176:179], v[128:131]
    s_waitcnt lgkmcnt(0)
    v_mfma_f32_16x16x32_bf16 v[132:135], a[164:167], v[168:171], v[132:135]
    s_add_u32 s63, s63, 1
    s_cmp_lg_u32 s63, 10
    v_mfma_f32_16x16x32_bf16 v[136:139], a[164:167], v[172:175], v[136:139]
    v_mfma_f32_16x16x32_bf16 v[140:143], a[164:167], v[176:179], v[140:143]
L_a2:
    s_cbranch_scc1 L_a
    global_load_dword v246, v245, s[26:27]
    v_and_b32 v249, 1, v240
    v_add_u32 v249, 1, v249
    v_xor_b32 v249, s54, v249
    v_lshlrev_b32 v249, 7, v249
    buffer_load_dword v245, v249, s[8:11], 0 offen sc1
    s_branch L_a
L_sk:
    s_barrier
    ds_read_b128 a[72:75], v221 offset:0
    ds_read_b128 a[76:79], v221 offset:6144
    ds_read_b128 a[80:83], v222 offset:0
    ds_read_b128 a[84:87], v222 offset:6144
    ds_read_b128 a[88:91], v221 offset:128
    ds_read_b128 a[92:95], v221 offset:6272
    ds_read_b128 a[96:99], v222 offset:128
    s_waitcnt lgkmcnt(6)
    v_mfma_f32_16x16x32_bf16 v[144:147], a[72:75], a[0:3], 0
    ds_read_b128 a[100:103], v222 offset:6272
    s_waitcnt lgkmcnt(6)
    v_mfma_f32_16x16x32_bf16 v[156:159], a[76:79], a[0:3], 0
    ds_read_b128 a[104:107], v221 offset:256
    s_waitcnt lgkmcnt(6)
    v_mfma_f32_16x16x32_bf16 v[144:147], a[80:83], a[12:15], v[144:147]
    ds_read_b128 a[108:111], v221 offset:6400
    s_waitcnt lgkmcnt(6)
    v_mfma_f32_16x16x32_bf16 v[156:159], a[84:87], a[12:15], v[156:159]
    ds_read_b128 a[112:115], v222 offset:256
    s_waitcnt lgkmcnt(6)
    v_mfma_f32_16x16x32_bf16 v[144:147], a[88:91], a[24:27], v[144:147]
    ds_read_b128 a[116:119], v222 offset:6400
    s_waitcnt lgkmcnt(6)
    v_mfma_f32_16x16x32_bf16 v[156:159], a[92:95], a[24:27], v[156:159]
    s_add_u32 s62, s62, 49152
    s_cmp_ge_u32 s62, 147456
    s_waitcnt lgkmcnt(5)
    v_mfma_f32_16x16x32_bf16 v[144:147], a[96:99], a[36:39], v[144:147]
    s_cselect_b32 s62, 0, s62
    s_cselect_b32 s68, 4294868992, s72
    s_waitcnt lgkmcnt(4)
    v_mfma_f32_16x16x32_bf16 v[156:159], a[100:103], a[36:39], v[156:159]
    s_waitcnt lgkmcnt(3)
    v_mfma_f32_16x16x32_bf16 v[144:147], a[104:107], a[48:51], v[144:147]
    v_add_u32 v221, s68, v221
    s_waitcnt lgkmcnt(2)
    v_mfma_f32_16x16x32_bf16 v[156:159], a[108:111], a[48:51], v[156:159]
    v_add_u32 v222, s68, v222
    s_waitcnt lgkmcnt(1)
    v_mfma_f32_16x16x32_bf16 v[144:147], a[112:115], a[60:63], v[144:147]
    s_waitcnt lgkmcnt(0)
    v_mfma_f32_16x16x32_bf16 v[156:159], a[116:119], a[60:63], v[156:159]
    v_mfma_f32_16x16x32_bf16 v[148:151], a[72:75], a[4:7], 0
    v_mfma_f32_16x16x32_bf16 v[160:163], a[76:79], a[4:7], 0
    v_mfma_f32_16x16x32_bf16 v[148:151], a[80:83], a[16:19], v[148:151]
    s_nop 2
    v_fma_f32 v209, v144, s56, -v187
    v_fma_f32 v210, v145, s56, -v187
    v_fma_f32 v211, v146, s56, -v187
    v_mfma_f32_16x16x32_bf16 v[160:163], a[84:87], a[16:19], v[160:163]
    v_fma_f32 v212, v147, s56, -v187
    v_fma_f32 v213, v156, s56, -v187
    v_fma_f32 v214, v157, s56, -v187
    v_mfma_f32_16x16x32_bf16 v[148:151], a[88:91], a[28:31], v[148:151]
    v_fma_f32 v227, v158, s56, -v187
    v_fma_f32 v228, v159, s56, -v187
    v_max3_f32 v192, v209, v210, v211
    v_mfma_f32_16x16x32_bf16 v[160:163], a[92:95], a[28:31], v[160:163]
    v_max3_f32 v192, v192, v212, v213
    v_max3_f32 v192, v192, v214, v227
    v_max_f32 v192, v192, v228
    v_mfma_f32_16x16x32_bf16 v[148:151], a[96:99], a[40:43], v[148:151]
    v_exp_f32 v209, v209
    v_exp_f32 v210, v210
    v_exp_f32 v211, v211
    v_mfma_f32_16x16x32_bf16 v[160:163], a[100:103], a[40:43], v[160:163]
    v_exp_f32 v212, v212
    v_exp_f32 v213, v213
    v_mfma_f32_16x16x32_bf16 v[148:151], a[104:107], a[52:55], v[148:151]
    v_exp_f32 v214, v214
    v_exp_f32 v227, v227
    v_exp_f32 v228, v228
    v_mfma_f32_16x16x32_bf16 v[160:163], a[108:111], a[52:55], v[160:163]
    v_add_f32 v195, v209, v210
    v_add_f32 v193, v211, v212
    v_add_f32 v195, v195, v213
    v_mfma_f32_16x16x32_bf16 v[148:151], a[112:115], a[64:67], v[148:151]
    v_add_f32 v193, v193, v214
    v_add_f32 v195, v195, v227
    v_add_f32 v193, v193, v228
    v_mfma_f32_16x16x32_bf16 v[160:163], a[116:119], a[64:67], v[160:163]
    v_cvt_pk_bf16_f32 v168, v209, v210
    v_cvt_pk_bf16_f32 v169, v211, v212
    v_cvt_pk_bf16_f32 v170, v213, v214
    v_mfma_f32_16x16x32_bf16 v[152:155], a[72:75], a[8:11], 0
    v_cvt_pk_bf16_f32 v171, v227, v228
    v_add_f32 v195, v195, v193
    v_mfma_f32_16x16x32_bf16 v[164:167], a[76:79], a[8:11], 0
    v_mfma_f32_16x16x32_bf16 v[152:155], a[80:83], a[20:23], v[152:155]
    v_fma_f32 v209, v148, s56, -v189
    v_fma_f32 v210, v149, s56, -v189
    v_fma_f32 v211, v150, s56, -v189
    v_fma_f32 v212, v151, s56, -v189
    v_mfma_f32_16x16x32_bf16 v[164:167], a[84:87], a[20:23], v[164:167]
    v_fma_f32 v213, v160, s56, -v189
    v_fma_f32 v214, v161, s56, -v189
    v_fma_f32 v227, v162, s56, -v189
    v_mfma_f32_16x16x32_bf16 v[152:155], a[88:91], a[32:35], v[152:155]
    v_fma_f32 v228, v163, s56, -v189
    v_max3_f32 v192, v192, v209, v210
    v_max3_f32 v192, v192, v211, v212
    v_mfma_f32_16x16x32_bf16 v[164:167], a[92:95], a[32:35], v[164:167]
    v_max3_f32 v192, v192, v213, v214
    v_max3_f32 v192, v192, v227, v228
    v_exp_f32 v209, v209
    v_mfma_f32_16x16x32_bf16 v[152:155], a[96:99], a[44:47], v[152:155]
    v_exp_f32 v210, v210
    v_exp_f32 v211, v211
    v_exp_f32 v212, v212
    v_mfma_f32_16x16x32_bf16 v[164:167], a[100:103], a[44:47], v[164:167]
    v_exp_f32 v213, v213
    v_exp_f32 v214, v214
    v_exp_f32 v227, v227
    v_mfma_f32_16x16x32_bf16 v[152:155], a[104:107], a[56:59], v[152:155]
    v_exp_f32 v228, v228
    v_add_f32 v196, v209, v210
    v_add_f32 v193, v211, v212
    v_mfma_f32_16x16x32_bf16 v[164:167], a[108:111], a[56:59], v[164:167]
    v_add_f32 v196, v196, v213
    v_add_f32 v193, v193, v214
    v_add_f32 v196, v196, v227
    v_mfma_f32_16x16x32_bf16 v[152:155], a[112:115], a[68:71], v[152:155]
    v_add_f32 v193, v193, v228
    v_cvt_pk_bf16_f32 v172, v209, v210
    v_cvt_pk_bf16_f32 v173, v211, v212
    v_mfma_f32_16x16x32_bf16 v[164:167], a[116:119], a[68:71], v[164:167]
    v_cvt_pk_bf16_f32 v174, v213, v214
    v_cvt_pk_bf16_f32 v175, v227, v228
    v_add_f32 v196, v196, v193
    s_nop 0
    v_fma_f32 v209, v152, s56, -v191
    v_fma_f32 v210, v153, s56, -v191
    v_fma_f32 v211, v154, s56, -v191
    v_fma_f32 v212, v155, s56, -v191
    v_fma_f32 v213, v164, s56, -v191
    v_fma_f32 v214, v165, s56, -v191
    v_fma_f32 v227, v166, s56, -v191
    v_fma_f32 v228, v167, s56, -v191
    v_max3_f32 v192, v192, v209, v210
    v_max3_f32 v192, v192, v211, v212
    v_max3_f32 v192, v192, v213, v214
    v_max3_f32 v192, v192, v227, v228
    v_exp_f32 v209, v209
    v_exp_f32 v210, v210
    v_exp_f32 v211, v211
    v_exp_f32 v212, v212
    v_exp_f32 v213, v213
    v_exp_f32 v214, v214
    v_exp_f32 v227, v227
    v_exp_f32 v228, v228
    v_add_f32 v197, v209, v210
    v_add_f32 v193, v211, v212
    v_add_f32 v197, v197, v213
    v_add_f32 v193, v193, v214
    v_add_f32 v197, v197, v227
    v_add_f32 v193, v193, v228
    v_cvt_pk_bf16_f32 v176, v209, v210
    v_cvt_pk_bf16_f32 v177, v211, v212
    v_cvt_pk_bf16_f32 v178, v213, v214
    v_cvt_pk_bf16_f32 v179, v227, v228
    v_add_f32 v197, v197, v193
    v_cmp_lt_f32 vcc, s91, v192
    s_cbranch_vccnz L_slow
L_ret3:
    v_add_f32 v183, v183, v195
    v_add_f32 v184, v184, v196
    v_add_f32 v185, v185, v197
    s_barrier
    ds_read_b64_tr_b16 a[120:121], v223 offset:0
    ds_read_b64_tr_b16 a[122:123], v223 offset:6144
    ds_read_b64_tr_b16 a[124:125], v224 offset:0
    ds_read_b64_tr_b16 a[126:127], v224 offset:6144
    ds_read_b64_tr_b16 a[128:129], v225 offset:0
    ds_read_b64_tr_b16 a[130:131], v225 offset:6144
    s_waitcnt lgkmcnt(4)
    v_mfma_f32_16x16x32_bf16 v[0:3], a[120:123], v[168:171], v[0:3]
    ds_read_b64_tr_b16 a[132:133], v226 offset:0
    v_mfma_f32_16x16x32_bf16 v[4:7], a[120:123], v[172:175], v[4:7]
    ds_read_b64_tr_b16 a[134:135], v226 offset:6144
    v_mfma_f32_16x16x32_bf16 v[8:11], a[120:123], v[176:179], v[8:11]
    ds_read_b64_tr_b16 a[136:137], v223 offset:128
    s_waitcnt lgkmcnt(5)
    v_mfma_f32_16x16x32_bf16 v[12:15], a[124:127], v[168:171], v[12:15]
    ds_read_b64_tr_b16 a[138:139], v223 offset:6272
    v_mfma_f32_16x16x32_bf16 v[16:19], a[124:127], v[172:175], v[16:19]
    v_mfma_f32_16x16x32_bf16 v[20:23], a[124:127], v[176:179], v[20:23]
    ds_read_b64_tr_b16 a[140:141], v224 offset:128
    s_waitcnt lgkmcnt(5)
    v_mfma_f32_16x16x32_bf16 v[24:27], a[128:131], v[168:171], v[24:27]
    ds_read_b64_tr_b16 a[142:143], v224 offset:6272
    v_mfma_f32_16x16x32_bf16 v[28:31], a[128:131], v[172:175], v[28:31]
    ds_read_b64_tr_b16 a[144:145], v225 offset:128
    v_mfma_f32_16x16x32_bf16 v[32:35], a[128:131], v[176:179], v[32:35]
    ds_read_b64_tr_b16 a[146:147], v225 offset:6272
    s_waitcnt lgkmcnt(6)
    v_mfma_f32_16x16x32_bf16 v[36:39], a[132:135], v[168:171], v[36:39]
    v_mfma_f32_16x16x32_bf16 v[40:43], a[132:135], v[172:175], v[40:43]
    ds_read_b64_tr_b16 a[148:149], v226 offset:128
    v_mfma_f32_16x16x32_bf16 v[44:47], a[132:135], v[176:179], v[44:47]
    ds_read_b64_tr_b16 a[150:151], v226 offset:6272
    s_waitcnt lgkmcnt(6)
    v_mfma_f32_16x16x32_bf16 v[48:51], a[136:139], v[168:171], v[48:51]
    ds_read_b64_tr_b16 a[152:153], v223 offset:256
    v_mfma_f32_16x16x32_bf16 v[52:55], a[136:139], v[172:175], v[52:55]
    v_mfma_f32_16x16x32_bf16 v[56:59], a[136:139], v[176:179], v[56:59]
    ds_read_b64_tr_b16 a[154:155], v223 offset:6400
    s_waitcnt lgkmcnt(6)
    v_mfma_f32_16x16x32_bf16 v[60:63], a[140:143], v[168:171], v[60:63]
    ds_read_b64_tr_b16 a[156:157], v224 offset:256
    v_mfma_f32_16x16x32_bf16 v[64:67], a[140:143], v[172:175], v[64:67]
    ds_read_b64_tr_b16 a[158:159], v224 offset:6400
    v_mfma_f32_16x16x32_bf16 v[68:71], a[140:143], v[176:179], v[68:71]
    ds_read_b64_tr_b16 a[160:161], v225 offset:256
    s_waitcnt lgkmcnt(7)
    v_mfma_f32_16x16x32_bf16 v[72:75], a[144:147], v[168:171], v[72:75]
    v_mfma_f32_16x16x32_bf16 v[76:79], a[144:147], v[172:175], v[76:79]
    ds_read_b64_tr_b16 a[162:163], v225 offset:6400
    v_mfma_f32_16x16x32_bf16 v[80:83], a[144:147], v[176:179], v[80:83]
    ds_read_b64_tr_b16 a[164:165], v226 offset:256
    s_waitcnt lgkmcnt(7)
    v_mfma_f32_16x16x32_bf16 v[84:87], a[148:151], v[168:171], v[84:87]
    ds_read_b64_tr_b16 a[166:167], v226 offset:6400
    v_mfma_f32_16x16x32_bf16 v[88:91], a[148:151], v[172:175], v[88:91]
    v_mfma_f32_16x16x32_bf16 v[92:95], a[148:151], v[176:179], v[92:95]
    s_waitcnt lgkmcnt(6)
    v_mfma_f32_16x16x32_bf16 v[96:99], a[152:155], v[168:171], v[96:99]
    v_add_u32 v223, s68, v223
    v_mfma_f32_16x16x32_bf16 v[100:103], a[152:155], v[172:175], v[100:103]
    v_add_u32 v224, s68, v224
    v_mfma_f32_16x16x32_bf16 v[104:107], a[152:155], v[176:179], v[104:107]
    v_add_u32 v225, s68, v225
    s_waitcnt lgkmcnt(4)
    v_mfma_f32_16x16x32_bf16 v[108:111], a[156:159], v[168:171], v[108:111]
    v_add_u32 v226, s68, v226
    v_mfma_f32_16x16x32_bf16 v[112:115], a[156:159], v[172:175], v[112:115]
    v_mfma_f32_16x16x32_bf16 v[116:119], a[156:159], v[176:179], v[116:119]
    s_waitcnt lgkmcnt(2)
    v_mfma_f32_16x16x32_bf16 v[120:123], a[160:163], v[168:171], v[120:123]
    v_mfma_f32_16x16x32_bf16 v[124:127], a[160:163], v[172:175], v[124:127]
    v_mfma_f32_16x16x32_bf16 v[128:131], a[160:163], v[176:179], v[128:131]
    s_waitcnt lgkmcnt(0)
    v_mfma_f32_16x16x32_bf16 v[132:135], a[164:167], v[168:171], v[132:135]
    s_add_u32 s63, s63, 1
    s_cmp_lg_u32 s63, 10
    v_mfma_f32_16x16x32_bf16 v[136:139], a[164:167], v[172:175], v[136:139]
    v_mfma_f32_16x16x32_bf16 v[140:143], a[164:167], v[176:179], v[140:143]
    s_branch L_a2
L_slow:
    v_max3_f32 v192, v180, v144, v145
    v_max3_f32 v193, v181, v148, v149
    v_max3_f32 v194, v182, v152, v153
    v_max3_f32 v192, v192, v146, v147
    v_max3_f32 v193, v193, v150, v151
    v_max3_f32 v194, v194, v154, v155
    v_max3_f32 v192, v192, v156, v157
    v_max3_f32 v193, v193, v160, v161
    v_max3_f32 v194, v194, v164, v165
    v_max3_f32 v192, v192, v158, v159
    v_max3_f32 v193, v193, v162, v163
    v_max3_f32 v194, v194, v166, v167
    v_mov_b32 v209, v192
    v_mov_b32 v210, v193
    v_mov_b32 v211, v194
    v_permlane32_swap_b32 v192, v209
    v_permlane32_swap_b32 v193, v210
    v_permlane32_swap_b32 v194, v211
    v_max_f32 v192, v192, v209
    v_max_f32 v193, v193, v210
    v_max_f32 v194, v194, v211
    v_mov_b32 v209, v192
    v_mov_b32 v210, v193
    v_mov_b32 v211, v194
    v_permlane16_swap_b32 v192, v209
    v_permlane16_swap_b32 v193, v210
    v_permlane16_swap_b32 v194, v211
    v_max_f32 v192, v192, v209
    v_max_f32 v193, v193, v210
    v_max_f32 v194, v194, v211
    v_sub_f32 v195, v180, v192
    v_sub_f32 v196, v181, v193
    v_sub_f32 v197, v182, v194
    v_mul_f32 v187, s56, v192
    v_mul_f32 v189, s56, v193
    v_mul_f32 v191, s56, v194
    v_mul_f32 v195, s56, v195
    v_mul_f32 v196, s56, v196
    v_mul_f32 v197, s56, v197
    v_mov_b32 v180, v192
    v_mov_b32 v181, v193
    v_mov_b32 v182, v194
    v_exp_f32 v186, v195
    v_exp_f32 v188, v196
    v_exp_f32 v190, v197
    v_fma_f32 v209, v144, s56, -v187
    v_fma_f32 v210, v145, s56, -v187
    v_fma_f32 v211, v146, s56, -v187
    v_fma_f32 v212, v147, s56, -v187
    v_fma_f32 v213, v156, s56, -v187
    v_fma_f32 v214, v157, s56, -v187
    v_fma_f32 v227, v158, s56, -v187
    v_fma_f32 v228, v159, s56, -v187
    v_exp_f32 v209, v209
    v_exp_f32 v210, v210
    v_exp_f32 v211, v211
    v_exp_f32 v212, v212
    v_exp_f32 v213, v213
    v_exp_f32 v214, v214
    v_exp_f32 v227, v227
    v_exp_f32 v228, v228
    v_add_f32 v195, v209, v210
    v_add_f32 v193, v211, v212
    v_add_f32 v195, v195, v213
    v_add_f32 v193, v193, v214
    v_add_f32 v195, v195, v227
    v_add_f32 v193, v193, v228
    v_cvt_pk_bf16_f32 v168, v209, v210
    v_cvt_pk_bf16_f32 v169, v211, v212
    v_cvt_pk_bf16_f32 v170, v213, v214
    v_cvt_pk_bf16_f32 v171, v227, v228
    v_add_f32 v195, v195, v193
    v_fma_f32 v209, v148, s56, -v189
    v_fma_f32 v210, v149, s56, -v189
    v_fma_f32 v211, v150, s56, -v189
    v_fma_f32 v212, v151, s56, -v189
    v_fma_f32 v213, v160, s56, -v189
    v_fma_f32 v214, v161, s56, -v189
    v_fma_f32 v227, v162, s56, -v189
    v_fma_f32 v228, v163, s56, -v189
    v_exp_f32 v209, v209
    v_exp_f32 v210, v210
    v_exp_f32 v211, v211
    v_exp_f32 v212, v212
    v_exp_f32 v213, v213
    v_exp_f32 v214, v214
    v_exp_f32 v227, v227
    v_exp_f32 v228, v228
    v_add_f32 v196, v209, v210
    v_add_f32 v193, v211, v212
    v_add_f32 v196, v196, v213
    v_add_f32 v193, v193, v214
    v_add_f32 v196, v196, v227
    v_add_f32 v193, v193, v228
    v_cvt_pk_bf16_f32 v172, v209, v210
    v_cvt_pk_bf16_f32 v173, v211, v212
    v_cvt_pk_bf16_f32 v174, v213, v214
    v_cvt_pk_bf16_f32 v175, v227, v228
    v_add_f32 v196, v196, v193
    v_fma_f32 v209, v152, s56, -v191
    v_fma_f32 v210, v153, s56, -v191
    v_fma_f32 v211, v154, s56, -v191
    v_fma_f32 v212, v155, s56, -v191
    v_fma_f32 v213, v164, s56, -v191
    v_fma_f32 v214, v165, s56, -v191
    v_fma_f32 v227, v166, s56, -v191
    v_fma_f32 v228, v167, s56, -v191
    v_exp_f32 v209, v209
    v_exp_f32 v210, v210
    v_exp_f32 v211, v211
    v_exp_f32 v212, v212
    v_exp_f32 v213, v213
    v_exp_f32 v214, v214
    v_exp_f32 v227, v227
    v_exp_f32 v228, v228
    v_add_f32 v197, v209, v210
    v_add_f32 v193, v211, v212
    v_add_f32 v197, v197, v213
    v_add_f32 v193, v193, v214
    v_add_f32 v197, v197, v227
    v_add_f32 v193, v193, v228
    v_cvt_pk_bf16_f32 v176, v209, v210
    v_cvt_pk_bf16_f32 v177, v211, v212
    v_cvt_pk_bf16_f32 v178, v213, v214
    v_cvt_pk_bf16_f32 v179, v227, v228
    v_add_f32 v197, v197, v193
    v_mul_f32 v183, v183, v186
    v_mul_f32 v184, v184, v188
    v_mul_f32 v185, v185, v190
    v_pk_mul_f32 v[0:1], v[0:1], v[186:187] op_sel_hi:[1,0]
    v_pk_mul_f32 v[2:3], v[2:3], v[186:187] op_sel_hi:[1,0]
    v_pk_mul_f32 v[4:5], v[4:5], v[188:189] op_sel_hi:[1,0]
    v_pk_mul_f32 v[6:7], v[6:7], v[188:189] op_sel_hi:[1,0]
    v_pk_mul_f32 v[8:9], v[8:9], v[190:191] op_sel_hi:[1,0]
    v_pk_mul_f32 v[10:11], v[10:11], v[190:191] op_sel_hi:[1,0]
    v_pk_mul_f32 v[12:13], v[12:13], v[186:187] op_sel_hi:[1,0]
    v_pk_mul_f32 v[14:15], v[14:15], v[186:187] op_sel_hi:[1,0]
    v_pk_mul_f32 v[16:17], v[16:17], v[188:189] op_sel_hi:[1,0]
    v_pk_mul_f32 v[18:19], v[18:19], v[188:189] op_sel_hi:[1,0]
    v_pk_mul_f32 v[20:21], v[20:21], v[190:191] op_sel_hi:[1,0]
    v_pk_mul_f32 v[22:23], v[22:23], v[190:191] op_sel_hi:[1,0]
    v_pk_mul_f32 v[24:25], v[24:25], v[186:187] op_sel_hi:[1,0]
    v_pk_mul_f32 v[26:27], v[26:27], v[186:187] op_sel_hi:[1,0]
    v_pk_mul_f32 v[28:29], v[28:29], v[188:189] op_sel_hi:[1,0]
    v_pk_mul_f32 v[30:31], v[30:31], v[188:189] op_sel_hi:[1,0]
    v_pk_mul_f32 v[32:33], v[32:33], v[190:191] op_sel_hi:[1,0]
    v_pk_mul_f32 v[34:35], v[34:35], v[190:191] op_sel_hi:[1,0]
    v_pk_mul_f32 v[36:37], v[36:37], v[186:187] op_sel_hi:[1,0]
    v_pk_mul_f32 v[38:39], v[38:39], v[186:187] op_sel_hi:[1,0]
    v_pk_mul_f32 v[40:41], v[40:41], v[188:189] op_sel_hi:[1,0]
    v_pk_mul_f32 v[42:43], v[42:43], v[188:189] op_sel_hi:[1,0]
    v_pk_mul_f32 v[44:45], v[44:45], v[190:191] op_sel_hi:[1,0]
    v_pk_mul_f32 v[46:47], v[46:47], v[190:191] op_sel_hi:[1,0]
    v_pk_mul_f32 v[48:49], v[48:49], v[186:187] op_sel_hi:[1,0]
    v_pk_mul_f32 v[50:51], v[50:51], v[186:187] op_sel_hi:[1,0]
    v_pk_mul_f32 v[52:53], v[52:53], v[188:189] op_sel_hi:[1,0]
    v_pk_mul_f32 v[54:55], v[54:55], v[188:189] op_sel_hi:[1,0]
    v_pk_mul_f32 v[56:57], v[56:57], v[190:191] op_sel_hi:[1,0]
    v_pk_mul_f32 v[58:59], v[58:59], v[190:191] op_sel_hi:[1,0]
    v_pk_mul_f32 v[60:61], v[60:61], v[186:187] op_sel_hi:[1,0]
    v_pk_mul_f32 v[62:63], v[62:63], v[186:187] op_sel_hi:[1,0]
    v_pk_mul_f32 v[64:65], v[64:65], v[188:189] op_sel_hi:[1,0]
    v_pk_mul_f32 v[66:67], v[66:67], v[188:189] op_sel_hi:[1,0]
    v_pk_mul_f32 v[68:69], v[68:69], v[190:191] op_sel_hi:[1,0]
    v_pk_mul_f32 v[70:71], v[70:71], v[190:191] op_sel_hi:[1,0]
    v_pk_mul_f32 v[72:73], v[72:73], v[186:187] op_sel_hi:[1,0]
    v_pk_mul_f32 v[74:75], v[74:75], v[186:187] op_sel_hi:[1,0]
    v_pk_mul_f32 v[76:77], v[76:77], v[188:189] op_sel_hi:[1,0]
    v_pk_mul_f32 v[78:79], v[78:79], v[188:189] op_sel_hi:[1,0]
    v_pk_mul_f32 v[80:81], v[80:81], v[190:191] op_sel_hi:[1,0]
    v_pk_mul_f32 v[82:83], v[82:83], v[190:191] op_sel_hi:[1,0]
    v_pk_mul_f32 v[84:85], v[84:85], v[186:187] op_sel_hi:[1,0]
    v_pk_mul_f32 v[86:87], v[86:87], v[186:187] op_sel_hi:[1,0]
    v_pk_mul_f32 v[88:89], v[88:89], v[188:189] op_sel_hi:[1,0]
    v_pk_mul_f32 v[90:91], v[90:91], v[188:189] op_sel_hi:[1,0]
    v_pk_mul_f32 v[92:93], v[92:93], v[190:191] op_sel_hi:[1,0]
    v_pk_mul_f32 v[94:95], v[94:95], v[190:191] op_sel_hi:[1,0]
    v_pk_mul_f32 v[96:97], v[96:97], v[186:187] op_sel_hi:[1,0]
    v_pk_mul_f32 v[98:99], v[98:99], v[186:187] op_sel_hi:[1,0]
    v_pk_mul_f32 v[100:101], v[100:101], v[188:189] op_sel_hi:[1,0]
    v_pk_mul_f32 v[102:103], v[102:103], v[188:189] op_sel_hi:[1,0]
    v_pk_mul_f32 v[104:105], v[104:105], v[190:191] op_sel_hi:[1,0]
    v_pk_mul_f32 v[106:107], v[106:107], v[190:191] op_sel_hi:[1,0]
    v_pk_mul_f32 v[108:109], v[108:109], v[186:187] op_sel_hi:[1,0]
    v_pk_mul_f32 v[110:111], v[110:111], v[186:187] op_sel_hi:[1,0]
    v_pk_mul_f32 v[112:113], v[112:113], v[188:189] op_sel_hi:[1,0]
    v_pk_mul_f32 v[114:115], v[114:115], v[188:189] op_sel_hi:[1,0]
    v_pk_mul_f32 v[116:117], v[116:117], v[190:191] op_sel_hi:[1,0]
    v_pk_mul_f32 v[118:119], v[118:119], v[190:191] op_sel_hi:[1,0]
    v_pk_mul_f32 v[120:121], v[120:121], v[186:187] op_sel_hi:[1,0]
    v_pk_mul_f32 v[122:123], v[122:123], v[186:187] op_sel_hi:[1,0]
    v_pk_mul_f32 v[124:125], v[124:125], v[188:189] op_sel_hi:[1,0]
    v_pk_mul_f32 v[126:127], v[126:127], v[188:189] op_sel_hi:[1,0]
    v_pk_mul_f32 v[128:129], v[128:129], v[190:191] op_sel_hi:[1,0]
    v_pk_mul_f32 v[130:131], v[130:131], v[190:191] op_sel_hi:[1,0]
    v_pk_mul_f32 v[132:133], v[132:133], v[186:187] op_sel_hi:[1,0]
    v_pk_mul_f32 v[134:135], v[134:135], v[186:187] op_sel_hi:[1,0]
    v_pk_mul_f32 v[136:137], v[136:137], v[188:189] op_sel_hi:[1,0]
    v_pk_mul_f32 v[138:139], v[138:139], v[188:189] op_sel_hi:[1,0]
    v_pk_mul_f32 v[140:141], v[140:141], v[190:191] op_sel_hi:[1,0]
    v_pk_mul_f32 v[142:143], v[142:143], v[190:191] op_sel_hi:[1,0]
    s_cmp_eq_u32 s90, 0
    s_cbranch_scc1 L_ret0
    s_cmp_eq_u32 s90, 2
    s_cbranch_scc1 L_ret2
    s_cmp_eq_u32 s90, 3
    s_cbranch_scc1 L_ret3
    v_fma_f32 v209, v144, s56, -v187
    v_fma_f32 v210, v145, s56, -v187
    v_fma_f32 v211, v146, s56, -v187
    v_fma_f32 v212, v147, s56, -v187
    v_fma_f32 v213, v156, s56, -v187
    v_fma_f32 v214, v157, s56, -v187
    v_fma_f32 v227, v158, s56, -v187
    v_fma_f32 v228, v159, s56, -v187
    v_exp_f32 v209, v209
    v_exp_f32 v210, v210
    v_exp_f32 v211, v211
    v_exp_f32 v212, v212
    v_exp_f32 v213, v213
    v_exp_f32 v214, v214
    v_exp_f32 v227, v227
    v_exp_f32 v228, v228
    v_add_f32 v195, v209, v210
    v_add_f32 v193, v211, v212
    v_add_f32 v195, v195, v213
    v_add_f32 v193, v193, v214
    v_add_f32 v195, v195, v227
    v_add_f32 v193, v193, v228
    v_add_f32 v195, v195, v193
    v_fma_f32 v200, v148, s56, -v189
    v_fma_f32 v201, v149, s56, -v189
    v_fma_f32 v202, v150, s56, -v189
    v_fma_f32 v203, v151, s56, -v189
    v_fma_f32 v204, v160, s56, -v189
    v_fma_f32 v205, v161, s56, -v189
    v_fma_f32 v206, v162, s56, -v189
    v_fma_f32 v207, v163, s56, -v189
    v_exp_f32 v200, v200
    v_exp_f32 v201, v201
    v_exp_f32 v202, v202
    v_exp_f32 v203, v203
    v_exp_f32 v204, v204
    v_exp_f32 v205, v205
    v_exp_f32 v206, v206
    v_exp_f32 v207, v207
    v_add_f32 v196, v200, v201
    v_add_f32 v193, v202, v203
    v_add_f32 v196, v196, v204
    v_add_f32 v193, v193, v205
    v_add_f32 v196, v196, v206
    v_add_f32 v193, v193, v207
    v_add_f32 v196, v196, v193
    v_fma_f32 v208, v152, s56, -v191
    v_fma_f32 v250, v153, s56, -v191
    v_fma_f32 v251, v154, s56, -v191
    v_fma_f32 v252, v155, s56, -v191
    v_fma_f32 v253, v164, s56, -v191
    v_fma_f32 v242, v165, s56, -v191
    v_fma_f32 v247, v166, s56, -v191
    v_fma_f32 v244, v167, s56, -v191
    v_exp_f32 v208, v208
    v_exp_f32 v250, v250
    v_exp_f32 v251, v251
    v_exp_f32 v252, v252
    v_exp_f32 v253, v253
    v_exp_f32 v242, v242
    v_exp_f32 v247, v247
    v_exp_f32 v244, v244
    v_add_f32 v197, v208, v250
    v_add_f32 v193, v251, v252
    v_add_f32 v197, v197, v253
    v_add_f32 v193, v193, v242
    v_add_f32 v197, v197, v247
    v_add_f32 v193, v193, v244
    v_add_f32 v197, v197, v193
    s_branch L_ret1
L_ae:
    s_mov_b32 s90, 2
    s_barrier
    ds_read_b128 a[72:75], v221 offset:0
    ds_read_b128 a[76:79], v221 offset:6144
    ds_read_b128 a[80:83], v222 offset:0
    ds_read_b128 a[84:87], v222 offset:6144
    ds_read_b128 a[88:91], v221 offset:128
    ds_read_b128 a[92:95], v221 offset:6272
    ds_read_b128 a[96:99], v222 offset:128
    s_waitcnt lgkmcnt(6)
    v_mfma_f32_16x16x32_bf16 v[144:147], a[72:75], a[0:3], 0
    ds_read_b128 a[100:103], v222 offset:6272
    s_waitcnt lgkmcnt(6)
    v_mfma_f32_16x16x32_bf16 v[156:159], a[76:79], a[0:3], 0
    ds_read_b128 a[104:107], v221 offset:256
    s_waitcnt lgkmcnt(6)
    v_mfma_f32_16x16x32_bf16 v[144:147], a[80:83], a[12:15], v[144:147]
    ds_read_b128 a[108:111], v221 offset:6400
    s_waitcnt lgkmcnt(6)
    v_mfma_f32_16x16x32_bf16 v[156:159], a[84:87], a[12:15], v[156:159]
    ds_read_b128 a[112:115], v222 offset:256
    s_waitcnt lgkmcnt(6)
    v_mfma_f32_16x16x32_bf16 v[144:147], a[88:91], a[24:27], v[144:147]
    ds_read_b128 a[116:119], v222 offset:6400
    s_waitcnt lgkmcnt(6)
    v_mfma_f32_16x16x32_bf16 v[156:159], a[92:95], a[24:27], v[156:159]
    s_add_u32 s62, s62, 49152
    s_cmp_ge_u32 s62, 147456
    s_waitcnt lgkmcnt(5)
    v_mfma_f32_16x16x32_bf16 v[144:147], a[96:99], a[36:39], v[144:147]
    s_cselect_b32 s62, 0, s62
    s_cselect_b32 s68, 4294868992, s72
    s_waitcnt lgkmcnt(4)
    v_mfma_f32_16x16x32_bf16 v[156:159], a[100:103], a[36:39], v[156:159]
    s_mov_b32 m0, s67
    s_waitcnt lgkmcnt(3)
    v_mfma_f32_16x16x32_bf16 v[144:147], a[104:107], a[48:51], v[144:147]
    v_add_u32 v221, s68, v221
    buffer_load_dwordx4 v206, s[40:43], s65 offen offset:0 nt lds
    s_waitcnt lgkmcnt(2)
    v_mfma_f32_16x16x32_bf16 v[156:159], a[108:111], a[48:51], v[156:159]
    v_add_u32 v222, s68, v222
    s_waitcnt lgkmcnt(1)
    v_mfma_f32_16x16x32_bf16 v[144:147], a[112:115], a[60:63], v[144:147]
    s_waitcnt lgkmcnt(0)
    v_mfma_f32_16x16x32_bf16 v[156:159], a[116:119], a[60:63], v[156:159]
    v_mfma_f32_16x16x32_bf16 v[148:151], a[72:75], a[4:7], 0
    v_mfma_f32_16x16x32_bf16 v[160:163], a[76:79], a[4:7], 0
    v_mfma_f32_16x16x32_bf16 v[148:151], a[80:83], a[16:19], v[148:151]
    buffer_load_dwordx4 v207, s[40:43], s65 offen offset:1024 nt lds
    s_nop 1
    v_fma_f32 v209, v144, s56, -v187
    v_fma_f32 v210, v145, s56, -v187
    v_fma_f32 v211, v146, s56, -v187
    v_mfma_f32_16x16x32_bf16 v[160:163], a[84:87], a[16:19], v[160:163]
    v_fma_f32 v212, v147, s56, -v187
    v_fma_f32 v213, v156, s56, -v187
    v_fma_f32 v214, v157, s56, -v187
    v_mfma_f32_16x16x32_bf16 v[148:151], a[88:91], a[28:31], v[148:151]
    v_fma_f32 v227, v158, s56, -v187
    v_fma_f32 v228, v159, s56, -v187
    v_max3_f32 v192, v209, v210, v211
    v_mfma_f32_16x16x32_bf16 v[160:163], a[92:95], a[28:31], v[160:163]
    v_max3_f32 v192, v192, v212, v213
    v_max3_f32 v192, v192, v214, v227
    v_max_f32 v192, v192, v228
    v_mfma_f32_16x16x32_bf16 v[148:151], a[96:99], a[40:43], v[148:151]
    v_exp_f32 v209, v209
    v_exp_f32 v210, v210
    v_exp_f32 v211, v211
    v_mfma_f32_16x16x32_bf16 v[160:163], a[100:103], a[40:43], v[160:163]
    v_exp_f32 v212, v212
    v_exp_f32 v213, v213
    v_mfma_f32_16x16x32_bf16 v[148:151], a[104:107], a[52:55], v[148:151]
    v_exp_f32 v214, v214
    v_exp_f32 v227, v227
    v_exp_f32 v228, v228
    v_mfma_f32_16x16x32_bf16 v[160:163], a[108:111], a[52:55], v[160:163]
    v_add_f32 v195, v209, v210
    v_add_f32 v193, v211, v212
    v_add_f32 v195, v195, v213
    v_mfma_f32_16x16x32_bf16 v[148:151], a[112:115], a[64:67], v[148:151]
    buffer_load_dwordx4 v208, s[40:43], s65 offen offset:2048 nt lds
    v_add_f32 v193, v193, v214
    v_add_f32 v195, v195, v227
    v_add_f32 v193, v193, v228
    v_mfma_f32_16x16x32_bf16 v[160:163], a[116:119], a[64:67], v[160:163]
    v_cvt_pk_bf16_f32 v168, v209, v210
    v_cvt_pk_bf16_f32 v169, v211, v212
    v_cvt_pk_bf16_f32 v170, v213, v214
    v_mfma_f32_16x16x32_bf16 v[152:155], a[72:75], a[8:11], 0
    v_cvt_pk_bf16_f32 v171, v227, v228
    v_add_f32 v195, v195, v193
    v_mfma_f32_16x16x32_bf16 v[164:167], a[76:79], a[8:11], 0
    v_mfma_f32_16x16x32_bf16 v[152:155], a[80:83], a[20:23], v[152:155]
    v_fma_f32 v209, v148, s56, -v189
    v_fma_f32 v210, v149, s56, -v189
    v_fma_f32 v211, v150, s56, -v189
    v_fma_f32 v212, v151, s56, -v189
    v_mfma_f32_16x16x32_bf16 v[164:167], a[84:87], a[20:23], v[164:167]
    v_fma_f32 v213, v160, s56, -v189
    v_fma_f32 v214, v161, s56, -v189
    v_fma_f32 v227, v162, s56, -v189
    v_mfma_f32_16x16x32_bf16 v[152:155], a[88:91], a[32:35], v[152:155]
    v_fma_f32 v228, v163, s56, -v189
    v_max3_f32 v192, v192, v209, v210
    v_max3_f32 v192, v192, v211, v212
    v_mfma_f32_16x16x32_bf16 v[164:167], a[92:95], a[32:35], v[164:167]
    s_add_u32 m0, s67, 3072
    s_add_u32 s73, s65, 3072
    v_max3_f32 v192, v192, v213, v214
    v_max3_f32 v192, v192, v227, v228
    v_exp_f32 v209, v209
    v_mfma_f32_16x16x32_bf16 v[152:155], a[96:99], a[44:47], v[152:155]
    buffer_load_dwordx4 v206, s[40:43], s73 offen offset:0 nt lds
    v_exp_f32 v210, v210
    v_exp_f32 v211, v211
    v_exp_f32 v212, v212
    v_mfma_f32_16x16x32_bf16 v[164:167], a[100:103], a[44:47], v[164:167]
    v_exp_f32 v213, v213
    v_exp_f32 v214, v214
    v_exp_f32 v227, v227
    v_mfma_f32_16x16x32_bf16 v[152:155], a[104:107], a[56:59], v[152:155]
    v_exp_f32 v228, v228
    v_add_f32 v196, v209, v210
    v_add_f32 v193, v211, v212
    v_mfma_f32_16x16x32_bf16 v[164:167], a[108:111], a[56:59], v[164:167]
    v_add_f32 v196, v196, v213
    v_add_f32 v193, v193, v214
    v_add_f32 v196, v196, v227
    v_mfma_f32_16x16x32_bf16 v[152:155], a[112:115], a[68:71], v[152:155]
    v_add_f32 v193, v193, v228
    v_cvt_pk_bf16_f32 v172, v209, v210
    v_cvt_pk_bf16_f32 v173, v211, v212
    v_mfma_f32_16x16x32_bf16 v[164:167], a[116:119], a[68:71], v[164:167]
    v_cvt_pk_bf16_f32 v174, v213, v214
    v_cvt_pk_bf16_f32 v175, v227, v228
    v_add_f32 v196, v196, v193
    s_nop 0
    v_fma_f32 v209, v152, s56, -v191
    v_fma_f32 v210, v153, s56, -v191
    v_fma_f32 v211, v154, s56, -v191
    buffer_load_dwordx4 v207, s[40:43], s73 offen offset:1024 nt lds
    v_fma_f32 v212, v155, s56, -v191
    v_fma_f32 v213, v164, s56, -v191
    v_fma_f32 v214, v165, s56, -v191
    v_fma_f32 v227, v166, s56, -v191
    v_fma_f32 v228, v167, s56, -v191
    v_max3_f32 v192, v192, v209, v210
    v_max3_f32 v192, v192, v211, v212
    v_max3_f32 v192, v192, v213, v214
    v_max3_f32 v192, v192, v227, v228
    v_exp_f32 v209, v209
    v_exp_f32 v210, v210
    v_exp_f32 v211, v211
    buffer_load_dwordx4 v208, s[40:43], s73 offen offset:2048 nt lds
    v_exp_f32 v212, v212
    v_exp_f32 v213, v213
    v_exp_f32 v214, v214
    v_exp_f32 v227, v227
    v_exp_f32 v228, v228
    v_add_f32 v197, v209, v210
    v_add_f32 v193, v211, v212
    v_add_f32 v197, v197, v213
    v_add_f32 v193, v193, v214
    v_add_f32 v197, v197, v227
    v_add_f32 v193, v193, v228
    v_cvt_pk_bf16_f32 v176, v209, v210
    v_cvt_pk_bf16_f32 v177, v211, v212
    v_cvt_pk_bf16_f32 v178, v213, v214
    v_cvt_pk_bf16_f32 v179, v227, v228
    v_add_f32 v197, v197, v193
    v_cmp_lt_f32 vcc, s91, v192
    s_cbranch_vccnz L_slow
L_ret2:
    v_add_f32 v183, v183, v195
    v_add_f32 v184, v184, v196
    v_add_f32 v185, v185, v197
    s_barrier
    ds_read_b64_tr_b16 a[120:121], v223 offset:0
    ds_read_b64_tr_b16 a[122:123], v223 offset:6144
    ds_read_b64_tr_b16 a[124:125], v224 offset:0
    ds_read_b64_tr_b16 a[126:127], v224 offset:6144
    ds_read_b64_tr_b16 a[128:129], v225 offset:0
    ds_read_b64_tr_b16 a[130:131], v225 offset:6144
    s_waitcnt lgkmcnt(4)
    v_mfma_f32_16x16x32_bf16 v[0:3], a[120:123], v[168:171], v[0:3]
    ds_read_b64_tr_b16 a[132:133], v226 offset:0
    v_mfma_f32_16x16x32_bf16 v[4:7], a[120:123], v[172:175], v[4:7]
    ds_read_b64_tr_b16 a[134:135], v226 offset:6144
    v_mfma_f32_16x16x32_bf16 v[8:11], a[120:123], v[176:179], v[8:11]
    ds_read_b64_tr_b16 a[136:137], v223 offset:128
    s_waitcnt lgkmcnt(5)
    v_mfma_f32_16x16x32_bf16 v[12:15], a[124:127], v[168:171], v[12:15]
    ds_read_b64_tr_b16 a[138:139], v223 offset:6272
    v_mfma_f32_16x16x32_bf16 v[16:19], a[124:127], v[172:175], v[16:19]
    v_mfma_f32_16x16x32_bf16 v[20:23], a[124:127], v[176:179], v[20:23]
    ds_read_b64_tr_b16 a[140:141], v224 offset:128
    s_waitcnt lgkmcnt(5)
    v_mfma_f32_16x16x32_bf16 v[24:27], a[128:131], v[168:171], v[24:27]
    ds_read_b64_tr_b16 a[142:143], v224 offset:6272
    v_mfma_f32_16x16x32_bf16 v[28:31], a[128:131], v[172:175], v[28:31]
    ds_read_b64_tr_b16 a[144:145], v225 offset:128
    v_mfma_f32_16x16x32_bf16 v[32:35], a[128:131], v[176:179], v[32:35]
    ds_read_b64_tr_b16 a[146:147], v225 offset:6272
    s_waitcnt lgkmcnt(6)
    v_mfma_f32_16x16x32_bf16 v[36:39], a[132:135], v[168:171], v[36:39]
    v_mfma_f32_16x16x32_bf16 v[40:43], a[132:135], v[172:175], v[40:43]
    ds_read_b64_tr_b16 a[148:149], v226 offset:128
    v_mfma_f32_16x16x32_bf16 v[44:47], a[132:135], v[176:179], v[44:47]
    ds_read_b64_tr_b16 a[150:151], v226 offset:6272
    s_waitcnt lgkmcnt(6)
    v_mfma_f32_16x16x32_bf16 v[48:51], a[136:139], v[168:171], v[48:51]
    ds_read_b64_tr_b16 a[152:153], v223 offset:256
    v_mfma_f32_16x16x32_bf16 v[52:55], a[136:139], v[172:175], v[52:55]
    v_mfma_f32_16x16x32_bf16 v[56:59], a[136:139], v[176:179], v[56:59]
    ds_read_b64_tr_b16 a[154:155], v223 offset:6400
    s_waitcnt lgkmcnt(6)
    v_mfma_f32_16x16x32_bf16 v[60:63], a[140:143], v[168:171], v[60:63]
    ds_read_b64_tr_b16 a[156:157], v224 offset:256
    v_mfma_f32_16x16x32_bf16 v[64:67], a[140:143], v[172:175], v[64:67]
    ds_read_b64_tr_b16 a[158:159], v224 offset:6400
    v_mfma_f32_16x16x32_bf16 v[68:71], a[140:143], v[176:179], v[68:71]
    ds_read_b64_tr_b16 a[160:161], v225 offset:256
    s_waitcnt lgkmcnt(7)
    v_mfma_f32_16x16x32_bf16 v[72:75], a[144:147], v[168:171], v[72:75]
    v_mfma_f32_16x16x32_bf16 v[76:79], a[144:147], v[172:175], v[76:79]
    ds_read_b64_tr_b16 a[162:163], v225 offset:6400
    v_mfma_f32_16x16x32_bf16 v[80:83], a[144:147], v[176:179], v[80:83]
    ds_read_b64_tr_b16 a[164:165], v226 offset:256
    s_waitcnt lgkmcnt(7)
    v_mfma_f32_16x16x32_bf16 v[84:87], a[148:151], v[168:171], v[84:87]
    ds_read_b64_tr_b16 a[166:167], v226 offset:6400
    v_mfma_f32_16x16x32_bf16 v[88:91], a[148:151], v[172:175], v[88:91]
    v_mfma_f32_16x16x32_bf16 v[92:95], a[148:151], v[176:179], v[92:95]
    s_waitcnt lgkmcnt(6)
    v_mfma_f32_16x16x32_bf16 v[96:99], a[152:155], v[168:171], v[96:99]
    v_add_u32 v223, s68, v223
    v_mfma_f32_16x16x32_bf16 v[100:103], a[152:155], v[172:175], v[100:103]
    v_add_u32 v224, s68, v224
    v_mfma_f32_16x16x32_bf16 v[104:107], a[152:155], v[176:179], v[104:107]
    v_add_u32 v225, s68, v225
    s_waitcnt lgkmcnt(4)
    v_mfma_f32_16x16x32_bf16 v[108:111], a[156:159], v[168:171], v[108:111]
    v_add_u32 v226, s68, v226
    v_mfma_f32_16x16x32_bf16 v[112:115], a[156:159], v[172:175], v[112:115]
    v_mfma_f32_16x16x32_bf16 v[116:119], a[156:159], v[176:179], v[116:119]
    s_waitcnt lgkmcnt(2)
    v_mfma_f32_16x16x32_bf16 v[120:123], a[160:163], v[168:171], v[120:123]
    v_mfma_f32_16x16x32_bf16 v[124:127], a[160:163], v[172:175], v[124:127]
    v_mfma_f32_16x16x32_bf16 v[128:131], a[160:163], v[176:179], v[128:131]
    s_waitcnt lgkmcnt(0)
    v_mfma_f32_16x16x32_bf16 v[132:135], a[164:167], v[168:171], v[132:135]
    v_mfma_f32_16x16x32_bf16 v[136:139], a[164:167], v[172:175], v[136:139]
    v_mfma_f32_16x16x32_bf16 v[140:143], a[164:167], v[176:179], v[140:143]
    s_waitcnt vmcnt(6)
    s_mov_b32 s90, 1
    s_barrier
    ds_read_b128 a[72:75], v221 offset:0
    ds_read_b128 a[76:79], v221 offset:6144
    ds_read_b128 a[80:83], v222 offset:0
    ds_read_b128 a[84:87], v222 offset:6144
    ds_read_b128 a[88:91], v221 offset:128
    ds_read_b128 a[92:95], v221 offset:6272
    ds_read_b128 a[96:99], v222 offset:128
    s_waitcnt lgkmcnt(6)
    v_mfma_f32_16x16x32_bf16 v[144:147], a[72:75], a[0:3], 0
    ds_read_b128 a[100:103], v222 offset:6272
    s_waitcnt lgkmcnt(6)
    v_mfma_f32_16x16x32_bf16 v[156:159], a[76:79], a[0:3], 0
    ds_read_b128 a[104:107], v221 offset:256
    s_waitcnt lgkmcnt(6)
    v_mfma_f32_16x16x32_bf16 v[144:147], a[80:83], a[12:15], v[144:147]
    ds_read_b128 a[108:111], v221 offset:6400
    s_waitcnt lgkmcnt(6)
    v_mfma_f32_16x16x32_bf16 v[156:159], a[84:87], a[12:15], v[156:159]
    ds_read_b128 a[112:115], v222 offset:256
    s_waitcnt lgkmcnt(6)
    v_mfma_f32_16x16x32_bf16 v[144:147], a[88:91], a[24:27], v[144:147]
    ds_read_b128 a[116:119], v222 offset:6400
    s_waitcnt lgkmcnt(6)
    v_mfma_f32_16x16x32_bf16 v[156:159], a[92:95], a[24:27], v[156:159]
    s_add_u32 s62, s62, 49152
    s_cmp_ge_u32 s62, 147456
    s_waitcnt lgkmcnt(5)
    v_mfma_f32_16x16x32_bf16 v[144:147], a[96:99], a[36:39], v[144:147]
    s_cselect_b32 s62, 0, s62
    s_cselect_b32 s68, 4294868992, s72
    s_waitcnt lgkmcnt(4)
    v_mfma_f32_16x16x32_bf16 v[156:159], a[100:103], a[36:39], v[156:159]
    s_mov_b32 m0, s74
    s_add_u32 s72, s78, s83
    s_waitcnt lgkmcnt(3)
    v_mfma_f32_16x16x32_bf16 v[144:147], a[104:107], a[48:51], v[144:147]
    v_add_u32 v221, s68, v221
    buffer_load_dwordx4 v215, s[44:47], s72 offen offset:0  lds
    s_waitcnt lgkmcnt(2)
    v_mfma_f32_16x16x32_bf16 v[156:159], a[108:111], a[48:51], v[156:159]
    v_add_u32 v222, s68, v222
    s_waitcnt lgkmcnt(1)
    v_mfma_f32_16x16x32_bf16 v[144:147], a[112:115], a[60:63], v[144:147]
    s_waitcnt lgkmcnt(0)
    v_mfma_f32_16x16x32_bf16 v[156:159], a[116:119], a[60:63], v[156:159]
    v_mfma_f32_16x16x32_bf16 v[148:151], a[72:75], a[4:7], 0
    v_mfma_f32_16x16x32_bf16 v[160:163], a[76:79], a[4:7], 0
    v_mfma_f32_16x16x32_bf16 v[148:151], a[80:83], a[16:19], v[148:151]
    buffer_load_dwordx4 v216, s[44:47], s72 offen offset:1024  lds
    s_nop 1
    v_fma_f32 v209, v144, s56, -v187
    v_fma_f32 v210, v145, s56, -v187
    v_fma_f32 v211, v146, s56, -v187
    v_mfma_f32_16x16x32_bf16 v[160:163], a[84:87], a[16:19], v[160:163]
    v_fma_f32 v212, v147, s56, -v187
    v_fma_f32 v213, v156, s56, -v187
    v_mfma_f32_16x16x32_bf16 v[148:151], a[88:91], a[28:31], v[148:151]
    v_fma_f32 v214, v157, s56, -v187
    v_fma_f32 v227, v158, s56, -v187
    v_fma_f32 v228, v159, s56, -v187
    v_mfma_f32_16x16x32_bf16 v[160:163], a[92:95], a[28:31], v[160:163]
    v_max3_f32 v192, v209, v210, v211
    v_max3_f32 v192, v192, v212, v213
    v_mfma_f32_16x16x32_bf16 v[148:151], a[96:99], a[40:43], v[148:151]
    v_max3_f32 v192, v192, v214, v227
    v_max_f32 v192, v192, v228
    v_exp_f32 v209, v209
    v_mfma_f32_16x16x32_bf16 v[160:163], a[100:103], a[40:43], v[160:163]
    v_exp_f32 v210, v210
    v_exp_f32 v211, v211
    v_mfma_f32_16x16x32_bf16 v[148:151], a[104:107], a[52:55], v[148:151]
    v_exp_f32 v212, v212
    v_exp_f32 v213, v213
    v_exp_f32 v214, v214
    v_mfma_f32_16x16x32_bf16 v[160:163], a[108:111], a[52:55], v[160:163]
    v_exp_f32 v227, v227
    v_exp_f32 v228, v228
    v_mfma_f32_16x16x32_bf16 v[148:151], a[112:115], a[64:67], v[148:151]
    buffer_load_dwordx4 v217, s[44:47], s72 offen offset:2048  lds
    v_add_f32 v195, v209, v210
    v_add_f32 v193, v211, v212
    v_add_f32 v195, v195, v213
    v_mfma_f32_16x16x32_bf16 v[160:163], a[116:119], a[64:67], v[160:163]
    v_add_f32 v193, v193, v214
    v_add_f32 v195, v195, v227
    v_mfma_f32_16x16x32_bf16 v[152:155], a[72:75], a[8:11], 0
    v_add_f32 v193, v193, v228
    v_add_f32 v195, v195, v193
    v_mfma_f32_16x16x32_bf16 v[164:167], a[76:79], a[8:11], 0
    v_mfma_f32_16x16x32_bf16 v[152:155], a[80:83], a[20:23], v[152:155]
    v_fma_f32 v200, v148, s56, -v189
    v_fma_f32 v201, v149, s56, -v189
    v_fma_f32 v202, v150, s56, -v189
    v_mfma_f32_16x16x32_bf16 v[164:167], a[84:87], a[20:23], v[164:167]
    v_fma_f32 v203, v151, s56, -v189
    v_fma_f32 v204, v160, s56, -v189
    v_fma_f32 v205, v161, s56, -v189
    v_mfma_f32_16x16x32_bf16 v[152:155], a[88:91], a[32:35], v[152:155]
    v_fma_f32 v206, v162, s56, -v189
    v_fma_f32 v207, v163, s56, -v189
    v_max3_f32 v192, v192, v200, v201
    v_mfma_f32_16x16x32_bf16 v[164:167], a[92:95], a[32:35], v[164:167]
    s_add_u32 m0, s74, 3072
    v_max3_f32 v192, v192, v202, v203
    v_max3_f32 v192, v192, v204, v205
    v_mfma_f32_16x16x32_bf16 v[152:155], a[96:99], a[44:47], v[152:155]
    buffer_load_dwordx4 v218, s[44:47], s72 offen offset:0  lds
    v_max3_f32 v192, v192, v206, v207
    v_exp_f32 v200, v200
    v_exp_f32 v201, v201
    v_mfma_f32_16x16x32_bf16 v[164:167], a[100:103], a[44:47], v[164:167]
    v_exp_f32 v202, v202
    v_exp_f32 v203, v203
    v_exp_f32 v204, v204
    v_mfma_f32_16x16x32_bf16 v[152:155], a[104:107], a[56:59], v[152:155]
    v_exp_f32 v205, v205
    v_exp_f32 v206, v206
    v_mfma_f32_16x16x32_bf16 v[164:167], a[108:111], a[56:59], v[164:167]
    v_exp_f32 v207, v207
    v_add_f32 v196, v200, v201
    v_add_f32 v193, v202, v203
    v_mfma_f32_16x16x32_bf16 v[152:155], a[112:115], a[68:71], v[152:155]
    v_add_f32 v196, v196, v204
    v_add_f32 v193, v193, v205
    v_add_f32 v196, v196, v206
    v_mfma_f32_16x16x32_bf16 v[164:167], a[116:119], a[68:71], v[164:167]
    v_add_f32 v193, v193, v207
    v_add_f32 v196, v196, v193
    s_nop 1
    v_fma_f32 v208, v152, s56, -v191
    v_fma_f32 v250, v153, s56, -v191
    v_fma_f32 v251, v154, s56, -v191
    buffer_load_dwordx4 v219, s[44:47], s72 offen offset:1024  lds
    v_fma_f32 v252, v155, s56, -v191
    v_fma_f32 v253, v164, s56, -v191
    v_fma_f32 v242, v165, s56, -v191
    v_fma_f32 v247, v166, s56, -v191
    v_fma_f32 v244, v167, s56, -v191
    v_max3_f32 v192, v192, v208, v250
    v_max3_f32 v192, v192, v251, v252
    v_max3_f32 v192, v192, v253, v242
    v_max3_f32 v192, v192, v247, v244
    v_exp_f32 v208, v208
    v_exp_f32 v250, v250
    v_exp_f32 v251, v251
    buffer_load_dwordx4 v220, s[44:47], s72 offen offset:2048  lds
    v_exp_f32 v252, v252
    v_exp_f32 v253, v253
    v_exp_f32 v242, v242
    v_exp_f32 v247, v247
    v_exp_f32 v244, v244
    v_add_f32 v197, v208, v250
    v_add_f32 v193, v251, v252
    v_add_f32 v197, v197, v253
    v_add_f32 v193, v193, v242
    v_add_f32 v197, v197, v247
    v_add_f32 v193, v193, v244
    v_add_f32 v197, v197, v193
    v_cmp_lt_f32 vcc, s91, v192
    s_cbranch_vccnz L_slow
L_ret1:
    v_add_f32 v183, v183, v195
    v_add_f32 v184, v184, v196
    v_add_f32 v185, v185, v197
    s_lshr_b32 s70, s53, 1
    s_lshl_b32 s70, s70, 2
    s_add_u32 s70, s70, s52
    s_mul_i32 s70, s70, 7680
    s_and_b32 s71, s53, 1
    s_xor_b32 s73, s87, 3
    s_add_u32 s71, s71, s73
    s_add_u32 s71, s71, 3
    s_cmp_ge_u32 s71, 5
    s_cselect_b32 s73, 5, 0
    s_sub_u32 s71, s71, s73
    s_lshl_b32 s71, s71, 8
    s_add_u32 s70, s70, s71
    s_add_u32 s70, s70, 368640
    v_min_u32 v248, 11, v240
    v_lshrrev_b32 v249, 1, v248
    v_and_b32 v248, 1, v248
    v_mul_u32_u24 v249, 1280, v249
    v_lshl_add_u32 v248, v248, 7, v249
    buffer_load_dword v246, v248, s[44:47], s70 offen
    v_mov_b32 v195, v183
    v_mov_b32 v196, v184
    v_mov_b32 v197, v185
    v_permlane32_swap_b32 v183, v195
    v_permlane32_swap_b32 v184, v196
    v_permlane32_swap_b32 v185, v197
    v_add_f32 v183, v183, v195
    v_add_f32 v184, v184, v196
    v_add_f32 v185, v185, v197
    v_mov_b32 v195, v183
    v_mov_b32 v196, v184
    v_mov_b32 v197, v185
    v_permlane16_swap_b32 v183, v195
    v_permlane16_swap_b32 v184, v196
    v_permlane16_swap_b32 v185, v197
    v_add_f32 v183, v183, v195
    v_add_f32 v184, v184, v196
    v_add_f32 v185, v185, v197
    v_rcp_f32 v186, v183
    v_rcp_f32 v188, v184
    v_rcp_f32 v190, v185
    v_mul_f32 v209, v186, v209
    v_mul_f32 v210, v186, v210
    v_mul_f32 v211, v186, v211
    v_mul_f32 v212, v186, v212
    v_mul_f32 v213, v186, v213
    v_mul_f32 v214, v186, v214
    v_mul_f32 v227, v186, v227
    v_mul_f32 v228, v186, v228
    v_cvt_pk_bf16_f32 v168, v209, v210
    v_cvt_pk_bf16_f32 v169, v211, v212
    v_cvt_pk_bf16_f32 v170, v213, v214
    v_cvt_pk_bf16_f32 v171, v227, v228
    v_mul_f32 v200, v188, v200
    v_mul_f32 v201, v188, v201
    v_mul_f32 v202, v188, v202
    v_mul_f32 v203, v188, v203
    v_mul_f32 v204, v188, v204
    v_mul_f32 v205, v188, v205
    v_mul_f32 v206, v188, v206
    v_mul_f32 v207, v188, v207
    v_cvt_pk_bf16_f32 v172, v200, v201
    v_cvt_pk_bf16_f32 v173, v202, v203
    v_cvt_pk_bf16_f32 v174, v204, v205
    v_cvt_pk_bf16_f32 v175, v206, v207
    v_mul_f32 v208, v190, v208
    v_mul_f32 v250, v190, v250
    v_mul_f32 v251, v190, v251
    v_mul_f32 v252, v190, v252
    v_mul_f32 v253, v190, v253
    v_mul_f32 v242, v190, v242
    v_mul_f32 v247, v190, v247
    v_mul_f32 v244, v190, v244
    v_cvt_pk_bf16_f32 v176, v208, v250
    v_cvt_pk_bf16_f32 v177, v251, v252
    v_cvt_pk_bf16_f32 v178, v253, v242
    v_cvt_pk_bf16_f32 v179, v247, v244
    v_pk_mul_f32 v[0:1], v[0:1], v[186:187] op_sel_hi:[1,0]
    s_add_u32 m0, s74, 24576
    s_add_u32 s72, s78, s84
    buffer_load_dwordx4 v215, s[44:47], s72 offen offset:0  lds
    v_pk_mul_f32 v[2:3], v[2:3], v[186:187] op_sel_hi:[1,0]
    v_pk_mul_f32 v[4:5], v[4:5], v[188:189] op_sel_hi:[1,0]
    v_pk_mul_f32 v[6:7], v[6:7], v[188:189] op_sel_hi:[1,0]
    v_pk_mul_f32 v[8:9], v[8:9], v[190:191] op_sel_hi:[1,0]
    v_pk_mul_f32 v[10:11], v[10:11], v[190:191] op_sel_hi:[1,0]
    v_pk_mul_f32 v[12:13], v[12:13], v[186:187] op_sel_hi:[1,0]
    v_pk_mul_f32 v[14:15], v[14:15], v[186:187] op_sel_hi:[1,0]
    v_pk_mul_f32 v[16:17], v[16:17], v[188:189] op_sel_hi:[1,0]
    v_pk_mul_f32 v[18:19], v[18:19], v[188:189] op_sel_hi:[1,0]
    v_pk_mul_f32 v[20:21], v[20:21], v[190:191] op_sel_hi:[1,0]
    v_pk_mul_f32 v[22:23], v[22:23], v[190:191] op_sel_hi:[1,0]
    v_pk_mul_f32 v[24:25], v[24:25], v[186:187] op_sel_hi:[1,0]
    buffer_load_dwordx4 v216, s[44:47], s72 offen offset:1024  lds
    v_pk_mul_f32 v[26:27], v[26:27], v[186:187] op_sel_hi:[1,0]
    v_pk_mul_f32 v[28:29], v[28:29], v[188:189] op_sel_hi:[1,0]
    v_pk_mul_f32 v[30:31], v[30:31], v[188:189] op_sel_hi:[1,0]
    v_pk_mul_f32 v[32:33], v[32:33], v[190:191] op_sel_hi:[1,0]
    v_pk_mul_f32 v[34:35], v[34:35], v[190:191] op_sel_hi:[1,0]
    v_pk_mul_f32 v[36:37], v[36:37], v[186:187] op_sel_hi:[1,0]
    v_pk_mul_f32 v[38:39], v[38:39], v[186:187] op_sel_hi:[1,0]
    v_pk_mul_f32 v[40:41], v[40:41], v[188:189] op_sel_hi:[1,0]
    v_pk_mul_f32 v[42:43], v[42:43], v[188:189] op_sel_hi:[1,0]
    v_pk_mul_f32 v[44:45], v[44:45], v[190:191] op_sel_hi:[1,0]
    v_pk_mul_f32 v[46:47], v[46:47], v[190:191] op_sel_hi:[1,0]
    v_pk_mul_f32 v[48:49], v[48:49], v[186:187] op_sel_hi:[1,0]
    buffer_load_dwordx4 v217, s[44:47], s72 offen offset:2048  lds
    v_pk_mul_f32 v[50:51], v[50:51], v[186:187] op_sel_hi:[1,0]
    v_pk_mul_f32 v[52:53], v[52:53], v[188:189] op_sel_hi:[1,0]
    v_pk_mul_f32 v[54:55], v[54:55], v[188:189] op_sel_hi:[1,0]
    v_pk_mul_f32 v[56:57], v[56:57], v[190:191] op_sel_hi:[1,0]
    v_pk_mul_f32 v[58:59], v[58:59], v[190:191] op_sel_hi:[1,0]
    v_pk_mul_f32 v[60:61], v[60:61], v[186:187] op_sel_hi:[1,0]
    v_pk_mul_f32 v[62:63], v[62:63], v[186:187] op_sel_hi:[1,0]
    v_pk_mul_f32 v[64:65], v[64:65], v[188:189] op_sel_hi:[1,0]
    v_pk_mul_f32 v[66:67], v[66:67], v[188:189] op_sel_hi:[1,0]
    v_pk_mul_f32 v[68:69], v[68:69], v[190:191] op_sel_hi:[1,0]
    v_pk_mul_f32 v[70:71], v[70:71], v[190:191] op_sel_hi:[1,0]
    v_pk_mul_f32 v[72:73], v[72:73], v[186:187] op_sel_hi:[1,0]
    s_add_u32 m0, s74, 27648
    s_nop 0
    buffer_load_dwordx4 v218, s[44:47], s72 offen offset:0  lds
    v_pk_mul_f32 v[74:75], v[74:75], v[186:187] op_sel_hi:[1,0]
    v_pk_mul_f32 v[76:77], v[76:77], v[188:189] op_sel_hi:[1,0]
    v_pk_mul_f32 v[78:79], v[78:79], v[188:189] op_sel_hi:[1,0]
    v_pk_mul_f32 v[80:81], v[80:81], v[190:191] op_sel_hi:[1,0]
    v_pk_mul_f32 v[82:83], v[82:83], v[190:191] op_sel_hi:[1,0]
    v_pk_mul_f32 v[84:85], v[84:85], v[186:187] op_sel_hi:[1,0]
    v_pk_mul_f32 v[86:87], v[86:87], v[186:187] op_sel_hi:[1,0]
    v_pk_mul_f32 v[88:89], v[88:89], v[188:189] op_sel_hi:[1,0]
    v_pk_mul_f32 v[90:91], v[90:91], v[188:189] op_sel_hi:[1,0]
    v_pk_mul_f32 v[92:93], v[92:93], v[190:191] op_sel_hi:[1,0]
    v_pk_mul_f32 v[94:95], v[94:95], v[190:191] op_sel_hi:[1,0]
    v_pk_mul_f32 v[96:97], v[96:97], v[186:187] op_sel_hi:[1,0]
    buffer_load_dwordx4 v219, s[44:47], s72 offen offset:1024  lds
    v_pk_mul_f32 v[98:99], v[98:99], v[186:187] op_sel_hi:[1,0]
    v_pk_mul_f32 v[100:101], v[100:101], v[188:189] op_sel_hi:[1,0]
    v_pk_mul_f32 v[102:103], v[102:103], v[188:189] op_sel_hi:[1,0]
    v_pk_mul_f32 v[104:105], v[104:105], v[190:191] op_sel_hi:[1,0]
    v_pk_mul_f32 v[106:107], v[106:107], v[190:191] op_sel_hi:[1,0]
    v_pk_mul_f32 v[108:109], v[108:109], v[186:187] op_sel_hi:[1,0]
    v_pk_mul_f32 v[110:111], v[110:111], v[186:187] op_sel_hi:[1,0]
    v_pk_mul_f32 v[112:113], v[112:113], v[188:189] op_sel_hi:[1,0]
    v_pk_mul_f32 v[114:115], v[114:115], v[188:189] op_sel_hi:[1,0]
    v_pk_mul_f32 v[116:117], v[116:117], v[190:191] op_sel_hi:[1,0]
    v_pk_mul_f32 v[118:119], v[118:119], v[190:191] op_sel_hi:[1,0]
    v_pk_mul_f32 v[120:121], v[120:121], v[186:187] op_sel_hi:[1,0]
    buffer_load_dwordx4 v220, s[44:47], s72 offen offset:2048  lds
    v_pk_mul_f32 v[122:123], v[122:123], v[186:187] op_sel_hi:[1,0]
    v_pk_mul_f32 v[124:125], v[124:125], v[188:189] op_sel_hi:[1,0]
    v_pk_mul_f32 v[126:127], v[126:127], v[188:189] op_sel_hi:[1,0]
    v_pk_mul_f32 v[128:129], v[128:129], v[190:191] op_sel_hi:[1,0]
    v_pk_mul_f32 v[130:131], v[130:131], v[190:191] op_sel_hi:[1,0]
    v_pk_mul_f32 v[132:133], v[132:133], v[186:187] op_sel_hi:[1,0]
    v_pk_mul_f32 v[134:135], v[134:135], v[186:187] op_sel_hi:[1,0]
    v_pk_mul_f32 v[136:137], v[136:137], v[188:189] op_sel_hi:[1,0]
    v_pk_mul_f32 v[138:139], v[138:139], v[188:189] op_sel_hi:[1,0]
    v_pk_mul_f32 v[140:141], v[140:141], v[190:191] op_sel_hi:[1,0]
    v_pk_mul_f32 v[142:143], v[142:143], v[190:191] op_sel_hi:[1,0]
    s_mul_i32 s70, s89, 393216
    s_add_u32 s28, s24, s70
    s_addc_u32 s29, s25, 0
    s_and_b32 s29, s29, 0xffff
    s_mov_b32 s30, 6684672
    s_mov_b32 s31, 0x20000
    s_add_u32 s32, s20, 0
    s_addc_u32 s33, s21, 0
    s_and_b32 s33, s33, 0xffff
    s_mov_b32 s34, 1966080
    s_mov_b32 s35, 0x20000
    s_waitcnt vmcnt(13)
    s_barrier
    ds_read_b64_tr_b16 a[120:121], v223 offset:0
    ds_read_b64_tr_b16 a[122:123], v223 offset:6144
    ds_read_b64_tr_b16 a[124:125], v224 offset:0
    ds_read_b64_tr_b16 a[126:127], v224 offset:6144
    ds_read_b64_tr_b16 a[128:129], v225 offset:0
    ds_read_b64_tr_b16 a[130:131], v225 offset:6144
    ds_read_b64_tr_b16 a[132:133], v226 offset:0
    ds_read_b64_tr_b16 a[134:135], v226 offset:6144
    ds_read_b64_tr_b16 a[136:137], v223 offset:128
    ds_read_b64_tr_b16 a[138:139], v223 offset:6272
    s_waitcnt lgkmcnt(8)
    v_mfma_f32_16x16x32_bf16 v[0:3], a[120:123], v[168:171], v[0:3]
    ds_read_b64_tr_b16 a[140:141], v224 offset:128
    ds_read_b64_tr_b16 a[142:143], v224 offset:6272
    v_mfma_f32_16x16x32_bf16 v[4:7], a[120:123], v[172:175], v[4:7]
    ds_read_b64_tr_b16 a[144:145], v225 offset:128
    v_mfma_f32_16x16x32_bf16 v[8:11], a[120:123], v[176:179], v[8:11]
    ds_read_b64_tr_b16 a[146:147], v225 offset:6272
    ds_read_b64_tr_b16 a[148:149], v226 offset:128
    s_waitcnt lgkmcnt(11)
    v_mfma_f32_16x16x32_bf16 v[12:15], a[124:127], v[168:171], v[12:15]
    ds_read_b64_tr_b16 a[150:151], v226 offset:6272
    v_mfma_f32_16x16x32_bf16 v[16:19], a[124:127], v[172:175], v[16:19]
    ds_read_b64_tr_b16 a[152:153], v223 offset:256
    v_mfma_f32_16x16x32_bf16 v[20:23], a[124:127], v[176:179], v[20:23]
    ds_read_b64_tr_b16 a[154:155], v223 offset:6400
    ds_read_b64_tr_b16 a[156:157], v224 offset:256
    s_waitcnt lgkmcnt(13)
    v_mfma_f32_16x16x32_bf16 v[24:27], a[128:131], v[168:171], v[24:27]
    ds_read_b64_tr_b16 a[158:159], v224 offset:6400
    v_mfma_f32_16x16x32_bf16 v[28:31], a[128:131], v[172:175], v[28:31]
    ds_read_b64_tr_b16 a[160:161], v225 offset:256
    ds_read_b64_tr_b16 a[162:163], v225 offset:6400
    v_mfma_f32_16x16x32_bf16 v[32:35], a[128:131], v[176:179], v[32:35]
    ds_read_b64_tr_b16 a[164:165], v226 offset:256
    s_waitcnt lgkmcnt(15)
    v_mfma_f32_16x16x32_bf16 v[36:39], a[132:135], v[168:171], v[36:39]
    ds_read_b64_tr_b16 a[166:167], v226 offset:6400
    v_mfma_f32_16x16x32_bf16 v[40:43], a[132:135], v[172:175], v[40:43]
    v_cvt_pk_bf16_f32 v0, v0, v1
    v_cvt_pk_bf16_f32 v1, v2, v3
    v_cvt_pk_bf16_f32 v2, v12, v13
    v_mfma_f32_16x16x32_bf16 v[44:47], a[132:135], v[176:179], v[44:47]
    v_cvt_pk_bf16_f32 v3, v14, v15
    ds_write_b128 v235, v[0:3] offset:0
    s_waitcnt lgkmcnt(15)
    v_mfma_f32_16x16x32_bf16 v[48:51], a[136:139], v[168:171], v[48:51]
    v_cvt_pk_bf16_f32 v4, v4, v5
    v_cvt_pk_bf16_f32 v5, v6, v7
    v_cvt_pk_bf16_f32 v6, v16, v17
    v_mfma_f32_16x16x32_bf16 v[52:55], a[136:139], v[172:175], v[52:55]
    v_cvt_pk_bf16_f32 v7, v18, v19
    ds_write_b128 v235, v[4:7] offset:1024
    v_mfma_f32_16x16x32_bf16 v[56:59], a[136:139], v[176:179], v[56:59]
    v_cvt_pk_bf16_f32 v8, v8, v9
    v_cvt_pk_bf16_f32 v9, v10, v11
    v_cvt_pk_bf16_f32 v10, v20, v21
    s_waitcnt lgkmcnt(14)
    v_mfma_f32_16x16x32_bf16 v[60:63], a[140:143], v[168:171], v[60:63]
    v_cvt_pk_bf16_f32 v11, v22, v23
    ds_write_b128 v235, v[8:11] offset:2048
    v_mfma_f32_16x16x32_bf16 v[64:67], a[140:143], v[172:175], v[64:67]
    v_cvt_pk_bf16_f32 v24, v24, v25
    v_cvt_pk_bf16_f32 v25, v26, v27
    v_cvt_pk_bf16_f32 v26, v36, v37
    v_mfma_f32_16x16x32_bf16 v[68:71], a[140:143], v[176:179], v[68:71]
    v_cvt_pk_bf16_f32 v27, v38, v39
    ds_write_b128 v235, v[24:27] offset:12288
    s_waitcnt lgkmcnt(14)
    v_mfma_f32_16x16x32_bf16 v[72:75], a[144:147], v[168:171], v[72:75]
    v_cvt_pk_bf16_f32 v28, v28, v29
    v_cvt_pk_bf16_f32 v29, v30, v31
    v_cvt_pk_bf16_f32 v30, v40, v41
    v_mfma_f32_16x16x32_bf16 v[76:79], a[144:147], v[172:175], v[76:79]
    v_cvt_pk_bf16_f32 v31, v42, v43
    ds_write_b128 v235, v[28:31] offset:13312
    v_mfma_f32_16x16x32_bf16 v[80:83], a[144:147], v[176:179], v[80:83]
    v_cvt_pk_bf16_f32 v32, v32, v33
    v_cvt_pk_bf16_f32 v33, v34, v35
    v_cvt_pk_bf16_f32 v34, v44, v45
    s_waitcnt lgkmcnt(13)
    v_mfma_f32_16x16x32_bf16 v[84:87], a[148:151], v[168:171], v[84:87]
    v_cvt_pk_bf16_f32 v35, v46, v47
    ds_write_b128 v235, v[32:35] offset:14336
    v_mfma_f32_16x16x32_bf16 v[88:91], a[148:151], v[172:175], v[88:91]
    v_cvt_pk_bf16_f32 v48, v48, v49
    v_cvt_pk_bf16_f32 v49, v50, v51
    v_cvt_pk_bf16_f32 v50, v60, v61
    v_mfma_f32_16x16x32_bf16 v[92:95], a[148:151], v[176:179], v[92:95]
    v_cvt_pk_bf16_f32 v51, v62, v63
    ds_write_b128 v235, v[48:51] offset:24576
    s_waitcnt lgkmcnt(13)
    v_mfma_f32_16x16x32_bf16 v[96:99], a[152:155], v[168:171], v[96:99]
    v_cvt_pk_bf16_f32 v52, v52, v53
    v_cvt_pk_bf16_f32 v53, v54, v55
    v_cvt_pk_bf16_f32 v54, v64, v65
    v_mfma_f32_16x16x32_bf16 v[100:103], a[152:155], v[172:175], v[100:103]
    v_cvt_pk_bf16_f32 v55, v66, v67
    ds_write_b128 v235, v[52:55] offset:25600
    v_mfma_f32_16x16x32_bf16 v[104:107], a[152:155], v[176:179], v[104:107]
    v_cvt_pk_bf16_f32 v56, v56, v57
    v_cvt_pk_bf16_f32 v57, v58, v59
    v_cvt_pk_bf16_f32 v58, v68, v69
    s_waitcnt lgkmcnt(12)
    v_mfma_f32_16x16x32_bf16 v[108:111], a[156:159], v[168:171], v[108:111]
    v_cvt_pk_bf16_f32 v59, v70, v71
    ds_write_b128 v235, v[56:59] offset:26624
    v_mfma_f32_16x16x32_bf16 v[112:115], a[156:159], v[172:175], v[112:115]
    v_cvt_pk_bf16_f32 v72, v72, v73
    v_cvt_pk_bf16_f32 v73, v74, v75
    v_mfma_f32_16x16x32_bf16 v[116:119], a[156:159], v[176:179], v[116:119]
    v_cvt_pk_bf16_f32 v74, v84, v85
    v_cvt_pk_bf16_f32 v75, v86, v87
    s_waitcnt lgkmcnt(11)
    v_mfma_f32_16x16x32_bf16 v[120:123], a[160:163], v[168:171], v[120:123]
    ds_write_b128 v235, v[72:75] offset:36864
    v_cvt_pk_bf16_f32 v76, v76, v77
    v_mfma_f32_16x16x32_bf16 v[124:127], a[160:163], v[172:175], v[124:127]
    v_cvt_pk_bf16_f32 v77, v78, v79
    v_cvt_pk_bf16_f32 v78, v88, v89
    v_mfma_f32_16x16x32_bf16 v[128:131], a[160:163], v[176:179], v[128:131]
    v_cvt_pk_bf16_f32 v79, v90, v91
    ds_write_b128 v235, v[76:79] offset:37888
    s_waitcnt lgkmcnt(11)
    v_mfma_f32_16x16x32_bf16 v[132:135], a[164:167], v[168:171], v[132:135]
    v_cvt_pk_bf16_f32 v80, v80, v81
    v_cvt_pk_bf16_f32 v81, v82, v83
    v_mfma_f32_16x16x32_bf16 v[136:139], a[164:167], v[172:175], v[136:139]
    v_cvt_pk_bf16_f32 v82, v92, v93
    v_cvt_pk_bf16_f32 v83, v94, v95
    v_mfma_f32_16x16x32_bf16 v[140:143], a[164:167], v[176:179], v[140:143]
    ds_write_b128 v235, v[80:83] offset:38912
    s_waitcnt vmcnt(7)
    s_barrier
    v_cvt_pk_bf16_f32 v96, v96, v97
    ds_read_b64_tr_b16 v[144:145], v229 offset:0
    v_cvt_pk_bf16_f32 v97, v98, v99
    v_cvt_pk_bf16_f32 v98, v108, v109
    ds_read_b64_tr_b16 v[146:147], v229 offset:4096
    s_add_u32 m0, s74, 49152
    s_add_u32 s72, s78, s85
    buffer_load_dwordx4 v215, s[44:47], s72 offen offset:0  lds
    v_cvt_pk_bf16_f32 v99, v110, v111
    ds_write_b128 v235, v[96:99] offset:49152
    v_cvt_pk_bf16_f32 v100, v100, v101
    ds_read_b64_tr_b16 v[148:149], v232 offset:0
    v_cvt_pk_bf16_f32 v101, v102, v103
    buffer_load_dwordx4 v216, s[44:47], s72 offen offset:1024  lds
    v_cvt_pk_bf16_f32 v102, v112, v113
    ds_read_b64_tr_b16 v[150:151], v232 offset:4096
    v_cvt_pk_bf16_f32 v103, v114, v115
    ds_write_b128 v235, v[100:103] offset:50176
    v_cvt_pk_bf16_f32 v104, v104, v105
    ds_read_b64_tr_b16 v[152:153], v229 offset:8192
    v_cvt_pk_bf16_f32 v105, v106, v107
    buffer_load_dwordx4 v217, s[44:47], s72 offen offset:2048  lds
    v_cvt_pk_bf16_f32 v106, v116, v117
    ds_read_b64_tr_b16 v[154:155], v229 offset:12288
    v_cvt_pk_bf16_f32 v107, v118, v119
    ds_write_b128 v235, v[104:107] offset:51200
    v_cvt_pk_bf16_f32 v120, v120, v121
    ds_read_b64_tr_b16 v[156:157], v232 offset:8192
    v_cvt_pk_bf16_f32 v121, v122, v123
    s_add_u32 m0, s74, 52224
    s_nop 0
    buffer_load_dwordx4 v218, s[44:47], s72 offen offset:0  lds
    v_cvt_pk_bf16_f32 v122, v132, v133
    ds_read_b64_tr_b16 v[158:159], v232 offset:12288
    v_cvt_pk_bf16_f32 v123, v134, v135
    ds_write_b128 v235, v[120:123] offset:61440
    v_cvt_pk_bf16_f32 v124, v124, v125
    ds_read_b64_tr_b16 v[160:161], v229 offset:16384
    buffer_load_dwordx4 v219, s[44:47], s72 offen offset:1024  lds
    v_cvt_pk_bf16_f32 v125, v126, v127
    v_cvt_pk_bf16_f32 v126, v136, v137
    ds_read_b64_tr_b16 v[162:163], v229 offset:20480
    v_cvt_pk_bf16_f32 v127, v138, v139
    ds_write_b128 v235, v[124:127] offset:62464
    v_cvt_pk_bf16_f32 v128, v128, v129
    ds_read_b64_tr_b16 v[164:165], v232 offset:16384
    buffer_load_dwordx4 v220, s[44:47], s72 offen offset:2048  lds
    v_cvt_pk_bf16_f32 v129, v130, v131
    v_cvt_pk_bf16_f32 v130, v140, v141
    ds_read_b64_tr_b16 v[166:167], v232 offset:20480
    v_cvt_pk_bf16_f32 v131, v142, v143
    ds_write_b128 v235, v[128:131] offset:63488
    s_mov_b32 s63, 0
    s_waitcnt vmcnt(6) lgkmcnt(0)
    s_barrier
    ds_read_b128 a[0:3], v236 offset:0
    ds_read_b128 a[4:7], v236 offset:1024
    ds_read_b128 a[8:11], v236 offset:2048
    ds_read_b128 a[12:15], v236 offset:3072
    ds_read_b128 a[16:19], v236 offset:4096
    ds_read_b128 a[20:23], v236 offset:5120
    s_waitcnt lgkmcnt(5)
    v_mfma_f32_16x16x32_bf16 v[0:3], v[144:147], a[0:3], 0
    s_mov_b32 m0, s74
    s_add_u32 s72, s78, s86
    ds_read_b128 a[24:27], v236 offset:12288
    ds_read_b128 a[28:31], v236 offset:13312
    v_mfma_f32_16x16x32_bf16 v[4:7], v[148:151], a[0:3], 0
    buffer_load_dwordx4 v215, s[44:47], s72 offen offset:0  lds
    s_waitcnt lgkmcnt(6)
    v_mfma_f32_16x16x32_bf16 v[12:15], v[148:151], a[4:7], 0
    s_mul_i32 s57, s54, 24576
    s_add_u32 s58, s57, 6291456
    s_xor_b32 s71, s54, 1
    ds_read_b128 a[32:35], v236 offset:14336
    v_mfma_f32_16x16x32_bf16 v[8:11], v[144:147], a[4:7], 0
    ds_read_b128 a[36:39], v236 offset:15360
    s_waitcnt lgkmcnt(7)
    v_mfma_f32_16x16x32_bf16 v[16:19], v[144:147], a[8:11], 0
    ds_read_b128 a[40:43], v236 offset:16384
    ds_read_b128 a[44:47], v236 offset:17408
    v_mfma_f32_16x16x32_bf16 v[20:23], v[148:151], a[8:11], 0
    ds_read_b128 a[48:51], v236 offset:24576
    s_waitcnt lgkmcnt(9)
    v_mfma_f32_16x16x32_bf16 v[28:31], v[148:151], a[12:15], 0
    buffer_load_dwordx4 v216, s[44:47], s72 offen offset:1024  lds
    v_mfma_f32_16x16x32_bf16 v[24:27], v[144:147], a[12:15], 0
    ds_read_b128 a[52:55], v236 offset:25600
    s_waitcnt lgkmcnt(9)
    v_mfma_f32_16x16x32_bf16 v[32:35], v[144:147], a[16:19], 0
    ds_read_b128 a[56:59], v236 offset:26624
    ds_read_b128 a[60:63], v236 offset:27648
    v_mfma_f32_16x16x32_bf16 v[36:39], v[148:151], a[16:19], 0
    s_mul_i32 s59, s71, 24576
    s_add_u32 s60, s59, 6291456
    s_lshl_b32 s64, s71, 7
    ds_read_b128 a[64:67], v236 offset:28672
    s_waitcnt lgkmcnt(11)
    v_mfma_f32_16x16x32_bf16 v[44:47], v[148:151], a[20:23], 0
    ds_read_b128 a[68:71], v236 offset:29696
    v_mfma_f32_16x16x32_bf16 v[40:43], v[144:147], a[20:23], 0
    buffer_load_dwordx4 v217, s[44:47], s72 offen offset:2048  lds
    s_waitcnt lgkmcnt(11)
    v_mfma_f32_16x16x32_bf16 v[0:3], v[152:155], a[24:27], v[0:3]
    ds_read_b64_tr_b16 v[96:97], v229 offset:24576
    ds_read_b64_tr_b16 v[98:99], v229 offset:28672
    v_mfma_f32_16x16x32_bf16 v[4:7], v[156:159], a[24:27], v[4:7]
    ds_read_b64_tr_b16 v[100:101], v232 offset:24576
    s_waitcnt lgkmcnt(13)
    v_mfma_f32_16x16x32_bf16 v[12:15], v[156:159], a[28:31], v[12:15]
    ds_read_b64_tr_b16 v[102:103], v232 offset:28672
    v_mfma_f32_16x16x32_bf16 v[8:11], v[152:155], a[28:31], v[8:11]
    s_add_u32 m0, s74, 3072
    ds_read_b64_tr_b16 v[104:105], v229 offset:32768
    s_waitcnt lgkmcnt(14)
    v_mfma_f32_16x16x32_bf16 v[16:19], v[152:155], a[32:35], v[16:19]
    buffer_load_dwordx4 v218, s[44:47], s72 offen offset:0  lds
    s_xor_b32 s71, s54, 3
    s_mul_i32 s61, s71, 24576
    v_mfma_f32_16x16x32_bf16 v[20:23], v[156:159], a[32:35], v[20:23]
    ds_read_b64_tr_b16 v[106:107], v229 offset:36864
    ds_read_b64_tr_b16 v[108:109], v232 offset:32768
    s_waitcnt lgkmcnt(15)
    v_mfma_f32_16x16x32_bf16 v[28:31], v[156:159], a[36:39], v[28:31]
    ds_read_b64_tr_b16 v[110:111], v232 offset:36864
    v_mfma_f32_16x16x32_bf16 v[24:27], v[152:155], a[36:39], v[24:27]
    ds_read_b64_tr_b16 v[112:113], v229 offset:40960
    s_waitcnt lgkmcnt(15)
    v_mfma_f32_16x16x32_bf16 v[32:35], v[152:155], a[40:43], v[32:35]
    ds_read_b64_tr_b16 v[114:115], v229 offset:45056
    ds_read_b64_tr_b16 v[116:117], v232 offset:40960
    v_mfma_f32_16x16x32_bf16 v[36:39], v[156:159], a[40:43], v[36:39]
    buffer_load_dwordx4 v219, s[44:47], s72 offen offset:1024  lds
    v_mfma_f32_16x16x32_bf16 v[44:47], v[156:159], a[44:47], v[44:47]
    ds_read_b64_tr_b16 v[118:119], v232 offset:45056
    v_mfma_f32_16x16x32_bf16 v[40:43], v[152:155], a[44:47], v[40:43]
    s_xor_b32 s71, s54, 2
    s_lshl_b32 s65, s71, 7
    ds_read_b128 a[72:75], v237 offset:0
    s_waitcnt lgkmcnt(15)
    v_mfma_f32_16x16x32_bf16 v[0:3], v[160:163], a[48:51], v[0:3]
    ds_read_b128 a[76:79], v237 offset:1024
    ds_read_b128 a[80:83], v237 offset:2048
    v_mfma_f32_16x16x32_bf16 v[4:7], v[164:167], a[48:51], v[4:7]
    ds_read_b128 a[84:87], v237 offset:3072
    v_mfma_f32_16x16x32_bf16 v[12:15], v[164:167], a[52:55], v[12:15]
    buffer_load_dwordx4 v220, s[44:47], s72 offen offset:2048  lds
    v_mfma_f32_16x16x32_bf16 v[8:11], v[160:163], a[52:55], v[8:11]
    ds_read_b128 a[88:91], v237 offset:4096
    v_mfma_f32_16x16x32_bf16 v[16:19], v[160:163], a[56:59], v[16:19]
    ds_read_b128 a[92:95], v237 offset:5120
    ds_read_b128 a[96:99], v237 offset:12288
    v_mfma_f32_16x16x32_bf16 v[20:23], v[164:167], a[56:59], v[20:23]
    ds_read_b128 a[100:103], v237 offset:13312
    v_mfma_f32_16x16x32_bf16 v[28:31], v[164:167], a[60:63], v[28:31]
    ds_read_b128 a[104:107], v237 offset:14336
    v_mfma_f32_16x16x32_bf16 v[24:27], v[160:163], a[60:63], v[24:27]
    ds_read_b128 a[108:111], v237 offset:15360
    s_waitcnt lgkmcnt(15)
    v_mfma_f32_16x16x32_bf16 v[32:35], v[160:163], a[64:67], v[32:35]
    v_mfma_f32_16x16x32_bf16 v[36:39], v[164:167], a[64:67], v[36:39]
    v_mfma_f32_16x16x32_bf16 v[44:47], v[164:167], a[68:71], v[44:47]
    v_mfma_f32_16x16x32_bf16 v[40:43], v[160:163], a[68:71], v[40:43]
    s_waitcnt vmcnt(6) lgkmcnt(0)
    s_barrier
    v_mfma_f32_16x16x32_bf16 v[0:3], v[96:99], a[72:75], v[0:3]
    s_add_u32 m0, s74, 24576
    s_add_u32 s72, s79, s83
    ds_read_b128 a[112:115], v237 offset:16384
    ds_read_b128 a[116:119], v237 offset:17408
    v_mfma_f32_16x16x32_bf16 v[4:7], v[100:103], a[72:75], v[4:7]
    buffer_load_dwordx4 v215, s[44:47], s72 offen offset:0  lds
    v_mfma_f32_16x16x32_bf16 v[12:15], v[100:103], a[76:79], v[12:15]
    ds_read_b128 a[120:123], v237 offset:24576
    v_mfma_f32_16x16x32_bf16 v[8:11], v[96:99], a[76:79], v[8:11]
    ds_read_b128 a[124:127], v237 offset:25600
    v_mfma_f32_16x16x32_bf16 v[16:19], v[96:99], a[80:83], v[16:19]
    ds_read_b128 a[128:131], v237 offset:26624
    ds_read_b128 a[132:135], v237 offset:27648
    v_mfma_f32_16x16x32_bf16 v[20:23], v[100:103], a[80:83], v[20:23]
    ds_read_b128 a[136:139], v237 offset:28672
    v_mfma_f32_16x16x32_bf16 v[28:31], v[100:103], a[84:87], v[28:31]
    buffer_load_dwordx4 v216, s[44:47], s72 offen offset:1024  lds
    v_mfma_f32_16x16x32_bf16 v[24:27], v[96:99], a[84:87], v[24:27]
    ds_read_b128 a[140:143], v237 offset:29696
    v_mfma_f32_16x16x32_bf16 v[32:35], v[96:99], a[88:91], v[32:35]
    ds_read_b128 a[144:147], v198 offset:0
    ds_read_b128 a[148:151], v198 offset:1024
    v_mfma_f32_16x16x32_bf16 v[36:39], v[100:103], a[88:91], v[36:39]
    ds_read_b128 a[152:155], v198 offset:2048
    v_mfma_f32_16x16x32_bf16 v[44:47], v[100:103], a[92:95], v[44:47]
    ds_read_b128 a[156:159], v198 offset:3072
    v_mfma_f32_16x16x32_bf16 v[40:43], v[96:99], a[92:95], v[40:43]
    buffer_load_dwordx4 v217, s[44:47], s72 offen offset:2048  lds
    v_mfma_f32_16x16x32_bf16 v[0:3], v[104:107], a[96:99], v[0:3]
    ds_read_b64_tr_b16 v[144:145], v230 offset:0
    ds_read_b64_tr_b16 v[146:147], v230 offset:4096
    v_mfma_f32_16x16x32_bf16 v[4:7], v[108:111], a[96:99], v[4:7]
    ds_read_b64_tr_b16 v[148:149], v233 offset:0
    v_mfma_f32_16x16x32_bf16 v[12:15], v[108:111], a[100:103], v[12:15]
    ds_read_b64_tr_b16 v[150:151], v233 offset:4096
    v_mfma_f32_16x16x32_bf16 v[8:11], v[104:107], a[100:103], v[8:11]
    s_add_u32 m0, s74, 27648
    ds_read_b64_tr_b16 v[152:153], v230 offset:8192
    v_mfma_f32_16x16x32_bf16 v[16:19], v[104:107], a[104:107], v[16:19]
    buffer_load_dwordx4 v218, s[44:47], s72 offen offset:0  lds
    v_mfma_f32_16x16x32_bf16 v[20:23], v[108:111], a[104:107], v[20:23]
    ds_read_b64_tr_b16 v[154:155], v230 offset:12288
    ds_read_b64_tr_b16 v[156:157], v233 offset:8192
    v_mfma_f32_16x16x32_bf16 v[28:31], v[108:111], a[108:111], v[28:31]
    ds_read_b64_tr_b16 v[158:159], v233 offset:12288
    v_mfma_f32_16x16x32_bf16 v[24:27], v[104:107], a[108:111], v[24:27]
    ds_read_b64_tr_b16 v[160:161], v230 offset:16384
    s_waitcnt lgkmcnt(15)
    v_mfma_f32_16x16x32_bf16 v[32:35], v[104:107], a[112:115], v[32:35]
    ds_read_b64_tr_b16 v[162:163], v230 offset:20480
    ds_read_b64_tr_b16 v[164:165], v233 offset:16384
    v_mfma_f32_16x16x32_bf16 v[36:39], v[108:111], a[112:115], v[36:39]
    buffer_load_dwordx4 v219, s[44:47], s72 offen offset:1024  lds
    v_mfma_f32_16x16x32_bf16 v[44:47], v[108:111], a[116:119], v[44:47]
    ds_read_b64_tr_b16 v[166:167], v233 offset:20480
    v_mfma_f32_16x16x32_bf16 v[40:43], v[104:107], a[116:119], v[40:43]
    ds_read_b128 a[160:163], v198 offset:4096
    v_mfma_f32_16x16x32_bf16 v[0:3], v[112:115], a[120:123], v[0:3]
    ds_read_b128 a[164:167], v198 offset:5120
    ds_read_b128 a[168:171], v198 offset:12288
    v_mfma_f32_16x16x32_bf16 v[4:7], v[116:119], a[120:123], v[4:7]
    ds_read_b128 a[172:175], v198 offset:13312
    v_mfma_f32_16x16x32_bf16 v[12:15], v[116:119], a[124:127], v[12:15]
    buffer_load_dwordx4 v220, s[44:47], s72 offen offset:2048  lds
    v_mfma_f32_16x16x32_bf16 v[8:11], v[112:115], a[124:127], v[8:11]
    ds_read_b128 a[176:179], v198 offset:14336
    v_mfma_f32_16x16x32_bf16 v[16:19], v[112:115], a[128:131], v[16:19]
    ds_read_b128 a[180:183], v198 offset:15360
    ds_read_b128 a[184:187], v198 offset:16384
    v_mfma_f32_16x16x32_bf16 v[20:23], v[116:119], a[128:131], v[20:23]
    ds_read_b128 a[188:191], v198 offset:17408
    v_mfma_f32_16x16x32_bf16 v[28:31], v[116:119], a[132:135], v[28:31]
    ds_read_b128 a[192:195], v198 offset:24576
    v_mfma_f32_16x16x32_bf16 v[24:27], v[112:115], a[132:135], v[24:27]
    ds_read_b128 a[196:199], v198 offset:25600
    s_waitcnt lgkmcnt(15)
    v_mfma_f32_16x16x32_bf16 v[32:35], v[112:115], a[136:139], v[32:35]
    v_mfma_f32_16x16x32_bf16 v[36:39], v[116:119], a[136:139], v[36:39]
    v_mfma_f32_16x16x32_bf16 v[44:47], v[116:119], a[140:143], v[44:47]
    v_mfma_f32_16x16x32_bf16 v[40:43], v[112:115], a[140:143], v[40:43]
    s_waitcnt vmcnt(6) lgkmcnt(0)
    s_barrier
    v_mfma_f32_16x16x32_bf16 v[0:3], v[144:147], a[144:147], v[0:3]
    s_add_u32 m0, s74, 49152
    s_add_u32 s72, s79, s84
    ds_read_b128 a[200:203], v198 offset:26624
    ds_read_b128 a[204:207], v198 offset:27648
    v_mfma_f32_16x16x32_bf16 v[4:7], v[148:151], a[144:147], v[4:7]
    buffer_load_dwordx4 v215, s[44:47], s72 offen offset:0  lds
    v_mfma_f32_16x16x32_bf16 v[12:15], v[148:151], a[148:151], v[12:15]
    ds_read_b128 a[208:211], v198 offset:28672
    v_mfma_f32_16x16x32_bf16 v[8:11], v[144:147], a[148:151], v[8:11]
    ds_read_b128 a[212:215], v198 offset:29696
    v_mfma_f32_16x16x32_bf16 v[16:19], v[144:147], a[152:155], v[16:19]
    ds_read_b128 a[216:219], v199 offset:0
    ds_read_b128 a[220:223], v199 offset:1024
    v_mfma_f32_16x16x32_bf16 v[20:23], v[148:151], a[152:155], v[20:23]
    ds_read_b128 a[224:227], v199 offset:2048
    v_mfma_f32_16x16x32_bf16 v[28:31], v[148:151], a[156:159], v[28:31]
    buffer_load_dwordx4 v216, s[44:47], s72 offen offset:1024  lds
    v_mfma_f32_16x16x32_bf16 v[24:27], v[144:147], a[156:159], v[24:27]
    ds_read_b128 a[228:231], v199 offset:3072
    v_mfma_f32_16x16x32_bf16 v[32:35], v[144:147], a[160:163], v[32:35]
    ds_read_b128 a[232:235], v199 offset:4096
    ds_read_b128 a[236:239], v199 offset:5120
    v_mfma_f32_16x16x32_bf16 v[36:39], v[148:151], a[160:163], v[36:39]
    ds_read_b128 a[240:243], v199 offset:12288
    v_mfma_f32_16x16x32_bf16 v[44:47], v[148:151], a[164:167], v[44:47]
    ds_read_b128 a[244:247], v199 offset:13312
    v_mfma_f32_16x16x32_bf16 v[40:43], v[144:147], a[164:167], v[40:43]
    buffer_load_dwordx4 v217, s[44:47], s72 offen offset:2048  lds
    v_mfma_f32_16x16x32_bf16 v[0:3], v[152:155], a[168:171], v[0:3]
    ds_read_b64_tr_b16 v[96:97], v229 offset:0
    ds_read_b64_tr_b16 v[98:99], v229 offset:4096
    v_mfma_f32_16x16x32_bf16 v[4:7], v[156:159], a[168:171], v[4:7]
    v_and_b32 v245, 0xff00, v245
    ds_read_b64_tr_b16 v[100:101], v232 offset:0
    v_mfma_f32_16x16x32_bf16 v[12:15], v[156:159], a[172:175], v[12:15]
    ds_read_b64_tr_b16 v[102:103], v232 offset:4096
    v_mfma_f32_16x16x32_bf16 v[8:11], v[152:155], a[172:175], v[8:11]
    s_add_u32 m0, s74, 52224
    ds_read_b64_tr_b16 v[104:105], v229 offset:8192
    v_mfma_f32_16x16x32_bf16 v[16:19], v[152:155], a[176:179], v[16:19]
    buffer_load_dwordx4 v218, s[44:47], s72 offen offset:0  lds
    v_mfma_f32_16x16x32_bf16 v[20:23], v[156:159], a[176:179], v[20:23]
    v_cmp_eq_u32 vcc, s0, v245
    ds_read_b64_tr_b16 v[106:107], v229 offset:12288
    ds_read_b64_tr_b16 v[108:109], v232 offset:8192
    v_mfma_f32_16x16x32_bf16 v[28:31], v[156:159], a[180:183], v[28:31]
    ds_read_b64_tr_b16 v[110:111], v232 offset:12288
    v_mfma_f32_16x16x32_bf16 v[24:27], v[152:155], a[180:183], v[24:27]
    ds_read_b64_tr_b16 v[112:113], v229 offset:16384
    v_mfma_f32_16x16x32_bf16 v[32:35], v[152:155], a[184:187], v[32:35]
    ds_read_b64_tr_b16 v[114:115], v229 offset:20480
    ds_read_b64_tr_b16 v[116:117], v232 offset:16384
    v_mfma_f32_16x16x32_bf16 v[36:39], v[156:159], a[184:187], v[36:39]
    buffer_load_dwordx4 v219, s[44:47], s72 offen offset:1024  lds
    v_mfma_f32_16x16x32_bf16 v[44:47], v[156:159], a[188:191], v[44:47]
    s_cmp_eq_u32 vcc_lo, -1
    s_cselect_b32 s1, 1, 0
    ds_read_b64_tr_b16 v[118:119], v232 offset:20480
    v_mfma_f32_16x16x32_bf16 v[40:43], v[152:155], a[188:191], v[40:43]
    ds_read_b128 a[248:251], v199 offset:14336
    v_mfma_f32_16x16x32_bf16 v[0:3], v[160:163], a[192:195], v[0:3]
    ds_read_b128 a[252:255], v199 offset:15360
    ds_read_b128 v[168:171], v199 offset:16384
    v_mfma_f32_16x16x32_bf16 v[4:7], v[164:167], a[192:195], v[4:7]
    ds_read_b128 v[172:175], v199 offset:17408
    v_mfma_f32_16x16x32_bf16 v[12:15], v[164:167], a[196:199], v[12:15]
    buffer_load_dwordx4 v220, s[44:47], s72 offen offset:2048  lds
    v_mfma_f32_16x16x32_bf16 v[8:11], v[160:163], a[196:199], v[8:11]
    ds_read_b128 v[176:179], v199 offset:24576
    s_waitcnt lgkmcnt(15)
    v_mfma_f32_16x16x32_bf16 v[16:19], v[160:163], a[200:203], v[16:19]
    ds_read_b128 v[180:183], v199 offset:25600
    ds_read_b128 v[184:187], v199 offset:26624
    v_mfma_f32_16x16x32_bf16 v[20:23], v[164:167], a[200:203], v[20:23]
    ds_read_b128 v[188:191], v199 offset:27648
    v_mfma_f32_16x16x32_bf16 v[28:31], v[164:167], a[204:207], v[28:31]
    ds_read_b128 v[192:195], v199 offset:28672
    v_mfma_f32_16x16x32_bf16 v[24:27], v[160:163], a[204:207], v[24:27]
    ds_read_b128 v[196:199], v199 offset:29696
    v_mfma_f32_16x16x32_bf16 v[32:35], v[160:163], a[208:211], v[32:35]
    v_mfma_f32_16x16x32_bf16 v[36:39], v[164:167], a[208:211], v[36:39]
    v_mfma_f32_16x16x32_bf16 v[44:47], v[164:167], a[212:215], v[44:47]
    v_mfma_f32_16x16x32_bf16 v[40:43], v[160:163], a[212:215], v[40:43]
    s_waitcnt vmcnt(6) lgkmcnt(0)
    s_barrier
    v_mfma_f32_16x16x32_bf16 v[0:3], v[96:99], a[216:219], v[0:3]
    s_mov_b32 m0, s74
    s_add_u32 s72, s79, s85
    buffer_load_dwordx4 v215, s[44:47], s72 offen offset:0  lds
    v_mfma_f32_16x16x32_bf16 v[4:7], v[100:103], a[216:219], v[4:7]
    ds_read_b64_tr_b16 v[144:145], v229 offset:24576
    v_mfma_f32_16x16x32_bf16 v[12:15], v[100:103], a[220:223], v[12:15]
    ds_read_b64_tr_b16 v[146:147], v229 offset:28672
    v_mfma_f32_16x16x32_bf16 v[8:11], v[96:99], a[220:223], v[8:11]
    v_mfma_f32_16x16x32_bf16 v[16:19], v[96:99], a[224:227], v[16:19]
    buffer_load_dwordx4 v216, s[44:47], s72 offen offset:1024  lds
    v_mfma_f32_16x16x32_bf16 v[20:23], v[100:103], a[224:227], v[20:23]
    ds_read_b64_tr_b16 v[148:149], v232 offset:24576
    v_mfma_f32_16x16x32_bf16 v[28:31], v[100:103], a[228:231], v[28:31]
    v_mfma_f32_16x16x32_bf16 v[24:27], v[96:99], a[228:231], v[24:27]
    ds_read_b64_tr_b16 v[150:151], v232 offset:28672
    v_mfma_f32_16x16x32_bf16 v[32:35], v[96:99], a[232:235], v[32:35]
    buffer_load_dwordx4 v217, s[44:47], s72 offen offset:2048  lds
    v_mfma_f32_16x16x32_bf16 v[36:39], v[100:103], a[232:235], v[36:39]
    v_mfma_f32_16x16x32_bf16 v[44:47], v[100:103], a[236:239], v[44:47]
    ds_read_b64_tr_b16 v[152:153], v229 offset:32768
    v_mfma_f32_16x16x32_bf16 v[40:43], v[96:99], a[236:239], v[40:43]
    s_add_u32 m0, s74, 3072
    v_mfma_f32_16x16x32_bf16 v[0:3], v[104:107], a[240:243], v[0:3]
    buffer_load_dwordx4 v218, s[44:47], s72 offen offset:0  lds
    v_mfma_f32_16x16x32_bf16 v[4:7], v[108:111], a[240:243], v[4:7]
    ds_read_b64_tr_b16 v[154:155], v229 offset:36864
    v_mfma_f32_16x16x32_bf16 v[12:15], v[108:111], a[244:247], v[12:15]
    v_mfma_f32_16x16x32_bf16 v[8:11], v[104:107], a[244:247], v[8:11]
    ds_read_b64_tr_b16 v[156:157], v232 offset:32768
    v_mfma_f32_16x16x32_bf16 v[16:19], v[104:107], a[248:251], v[16:19]
    buffer_load_dwordx4 v219, s[44:47], s72 offen offset:1024  lds
    v_mfma_f32_16x16x32_bf16 v[20:23], v[108:111], a[248:251], v[20:23]
    ds_read_b64_tr_b16 v[158:159], v232 offset:36864
    v_mfma_f32_16x16x32_bf16 v[28:31], v[108:111], a[252:255], v[28:31]
    v_mfma_f32_16x16x32_bf16 v[24:27], v[104:107], a[252:255], v[24:27]
    ds_read_b64_tr_b16 v[160:161], v229 offset:40960
    v_mfma_f32_16x16x32_bf16 v[32:35], v[104:107], v[168:171], v[32:35]
    buffer_load_dwordx4 v220, s[44:47], s72 offen offset:2048  lds
    v_mfma_f32_16x16x32_bf16 v[36:39], v[108:111], v[168:171], v[36:39]
    v_mfma_f32_16x16x32_bf16 v[44:47], v[108:111], v[172:175], v[44:47]
    ds_read_b64_tr_b16 v[162:163], v229 offset:45056
    v_mfma_f32_16x16x32_bf16 v[40:43], v[104:107], v[172:175], v[40:43]
    s_add_u32 m0, s74, 73728
    s_add_u32 s72, s79, s86
    v_mfma_f32_16x16x32_bf16 v[0:3], v[112:115], v[176:179], v[0:3]
    buffer_load_dwordx4 v215, s[44:47], s72 offen offset:0  lds
    v_mfma_f32_16x16x32_bf16 v[4:7], v[116:119], v[176:179], v[4:7]
    ds_read_b64_tr_b16 v[164:165], v232 offset:40960
    v_mfma_f32_16x16x32_bf16 v[12:15], v[116:119], v[180:183], v[12:15]
    v_mfma_f32_16x16x32_bf16 v[8:11], v[112:115], v[180:183], v[8:11]
    ds_read_b64_tr_b16 v[166:167], v232 offset:45056
    v_mfma_f32_16x16x32_bf16 v[16:19], v[112:115], v[184:187], v[16:19]
    buffer_load_dwordx4 v216, s[44:47], s72 offen offset:1024  lds
    v_mfma_f32_16x16x32_bf16 v[20:23], v[116:119], v[184:187], v[20:23]
    v_mfma_f32_16x16x32_bf16 v[28:31], v[116:119], v[188:191], v[28:31]
    v_mfma_f32_16x16x32_bf16 v[24:27], v[112:115], v[188:191], v[24:27]
    v_mfma_f32_16x16x32_bf16 v[32:35], v[112:115], v[192:195], v[32:35]
    buffer_load_dwordx4 v217, s[44:47], s72 offen offset:2048  lds
    v_mfma_f32_16x16x32_bf16 v[36:39], v[116:119], v[192:195], v[36:39]
    v_mfma_f32_16x16x32_bf16 v[44:47], v[116:119], v[196:199], v[44:47]
    v_mfma_f32_16x16x32_bf16 v[40:43], v[112:115], v[196:199], v[40:43]
    s_waitcnt vmcnt(9) lgkmcnt(0)
    s_barrier
    v_mfma_f32_16x16x32_bf16 v[48:51], v[144:147], a[0:3], 0
    s_add_u32 m0, s74, 76800
    s_nop 0
    buffer_load_dwordx4 v218, s[44:47], s72 offen offset:0  lds
    v_mfma_f32_16x16x32_bf16 v[52:55], v[148:151], a[0:3], 0
    ds_read_b64_tr_b16 v[96:97], v230 offset:0
    v_mfma_f32_16x16x32_bf16 v[60:63], v[148:151], a[4:7], 0
    ds_read_b64_tr_b16 v[98:99], v230 offset:4096
    v_mfma_f32_16x16x32_bf16 v[56:59], v[144:147], a[4:7], 0
    v_mfma_f32_16x16x32_bf16 v[64:67], v[144:147], a[8:11], 0
    buffer_load_dwordx4 v219, s[44:47], s72 offen offset:1024  lds
    v_mfma_f32_16x16x32_bf16 v[68:71], v[148:151], a[8:11], 0
    ds_read_b64_tr_b16 v[100:101], v233 offset:0
    v_mfma_f32_16x16x32_bf16 v[76:79], v[148:151], a[12:15], 0
    v_mfma_f32_16x16x32_bf16 v[72:75], v[144:147], a[12:15], 0
    ds_read_b64_tr_b16 v[102:103], v233 offset:4096
    v_mfma_f32_16x16x32_bf16 v[80:83], v[144:147], a[16:19], 0
    buffer_load_dwordx4 v220, s[44:47], s72 offen offset:2048  lds
    v_cvt_pk_bf16_f32 v0, v0, v1
    v_mfma_f32_16x16x32_bf16 v[84:87], v[148:151], a[16:19], 0
    v_cvt_pk_bf16_f32 v1, v2, v3
    v_mfma_f32_16x16x32_bf16 v[92:95], v[148:151], a[20:23], 0
    v_cvt_pk_bf16_f32 v2, v4, v5
    ds_read_b64_tr_b16 v[104:105], v230 offset:8192
    v_mfma_f32_16x16x32_bf16 v[88:91], v[144:147], a[20:23], 0
    v_cvt_pk_bf16_f32 v3, v6, v7
    v_mfma_f32_16x16x32_bf16 v[48:51], v[152:155], a[24:27], v[48:51]
    buffer_store_dwordx4 v[0:3], v238, s[28:31], s57 offen offset:0
    v_cvt_pk_bf16_f32 v8, v8, v9
    v_mfma_f32_16x16x32_bf16 v[52:55], v[156:159], a[24:27], v[52:55]
    v_cvt_pk_bf16_f32 v9, v10, v11
    ds_read_b64_tr_b16 v[106:107], v230 offset:12288
    v_mfma_f32_16x16x32_bf16 v[60:63], v[156:159], a[28:31], v[60:63]
    v_cvt_pk_bf16_f32 v10, v12, v13
    v_mfma_f32_16x16x32_bf16 v[56:59], v[152:155], a[28:31], v[56:59]
    v_cvt_pk_bf16_f32 v11, v14, v15
    ds_read_b64_tr_b16 v[108:109], v233 offset:8192
    v_mfma_f32_16x16x32_bf16 v[64:67], v[152:155], a[32:35], v[64:67]
    buffer_store_dwordx4 v[8:11], v238, s[28:31], s57 offen offset:1024
    v_cvt_pk_bf16_f32 v16, v16, v17
    v_mfma_f32_16x16x32_bf16 v[68:71], v[156:159], a[32:35], v[68:71]
    v_cvt_pk_bf16_f32 v17, v18, v19
    ds_read_b64_tr_b16 v[110:111], v233 offset:12288
    v_mfma_f32_16x16x32_bf16 v[76:79], v[156:159], a[36:39], v[76:79]
    v_cvt_pk_bf16_f32 v18, v20, v21
    v_mfma_f32_16x16x32_bf16 v[72:75], v[152:155], a[36:39], v[72:75]
    v_cvt_pk_bf16_f32 v19, v22, v23
    ds_read_b64_tr_b16 v[112:113], v230 offset:16384
    v_mfma_f32_16x16x32_bf16 v[80:83], v[152:155], a[40:43], v[80:83]
    buffer_store_dwordx4 v[16:19], v238, s[28:31], s57 offen offset:2048
    v_cvt_pk_bf16_f32 v24, v24, v25
    v_mfma_f32_16x16x32_bf16 v[84:87], v[156:159], a[40:43], v[84:87]
    v_cvt_pk_bf16_f32 v25, v26, v27
    v_mfma_f32_16x16x32_bf16 v[92:95], v[156:159], a[44:47], v[92:95]
    v_cvt_pk_bf16_f32 v26, v28, v29
    ds_read_b64_tr_b16 v[114:115], v230 offset:20480
    v_mfma_f32_16x16x32_bf16 v[88:91], v[152:155], a[44:47], v[88:91]
    v_cvt_pk_bf16_f32 v27, v30, v31
    v_mfma_f32_16x16x32_bf16 v[48:51], v[160:163], a[48:51], v[48:51]
    buffer_store_dwordx4 v[24:27], v239, s[28:31], s57 offen offset:0
    v_cvt_pk_bf16_f32 v32, v32, v33
    v_mfma_f32_16x16x32_bf16 v[52:55], v[164:167], a[48:51], v[52:55]
    v_cvt_pk_bf16_f32 v33, v34, v35
    ds_read_b64_tr_b16 v[116:117], v233 offset:16384
    v_mfma_f32_16x16x32_bf16 v[60:63], v[164:167], a[52:55], v[60:63]
    v_cvt_pk_bf16_f32 v34, v36, v37
    v_mfma_f32_16x16x32_bf16 v[56:59], v[160:163], a[52:55], v[56:59]
    v_cvt_pk_bf16_f32 v35, v38, v39
    ds_read_b64_tr_b16 v[118:119], v233 offset:20480
    v_mfma_f32_16x16x32_bf16 v[64:67], v[160:163], a[56:59], v[64:67]
    buffer_store_dwordx4 v[32:35], v239, s[28:31], s57 offen offset:1024
    v_cvt_pk_bf16_f32 v40, v40, v41
    v_mfma_f32_16x16x32_bf16 v[68:71], v[164:167], a[56:59], v[68:71]
    v_cvt_pk_bf16_f32 v41, v42, v43
    v_mfma_f32_16x16x32_bf16 v[76:79], v[164:167], a[60:63], v[76:79]
    v_cvt_pk_bf16_f32 v42, v44, v45
    v_mfma_f32_16x16x32_bf16 v[72:75], v[160:163], a[60:63], v[72:75]
    v_cvt_pk_bf16_f32 v43, v46, v47
    v_mfma_f32_16x16x32_bf16 v[80:83], v[160:163], a[64:67], v[80:83]
    buffer_store_dwordx4 v[40:43], v239, s[28:31], s57 offen offset:2048
    v_mfma_f32_16x16x32_bf16 v[84:87], v[164:167], a[64:67], v[84:87]
    v_mfma_f32_16x16x32_bf16 v[92:95], v[164:167], a[68:71], v[92:95]
    v_mfma_f32_16x16x32_bf16 v[88:91], v[160:163], a[68:71], v[88:91]
    s_waitcnt vmcnt(12) lgkmcnt(0)
    s_barrier
    v_mfma_f32_16x16x32_bf16 v[48:51], v[96:99], a[72:75], v[48:51]
    s_add_u32 m0, s74, 98304
    s_add_u32 s72, s80, s83
    buffer_load_dwordx4 v215, s[44:47], s72 offen offset:0  lds
    v_mfma_f32_16x16x32_bf16 v[52:55], v[100:103], a[72:75], v[52:55]
    ds_read_b64_tr_b16 v[144:145], v229 offset:0
    v_mfma_f32_16x16x32_bf16 v[60:63], v[100:103], a[76:79], v[60:63]
    s_mul_i32 s71, s54, 3
    s_add_u32 s71, s71, s52
    ds_read_b64_tr_b16 v[146:147], v229 offset:4096
    v_mfma_f32_16x16x32_bf16 v[56:59], v[96:99], a[76:79], v[56:59]
    v_mfma_f32_16x16x32_bf16 v[64:67], v[96:99], a[80:83], v[64:67]
    buffer_load_dwordx4 v216, s[44:47], s72 offen offset:1024  lds
    v_mfma_f32_16x16x32_bf16 v[68:71], v[100:103], a[80:83], v[68:71]
    ds_read_b64_tr_b16 v[148:149], v232 offset:0
    v_mfma_f32_16x16x32_bf16 v[76:79], v[100:103], a[84:87], v[76:79]
    s_cmp_ge_u32 s71, 24
    s_cselect_b32 s66, 6291456, 0
    s_cselect_b32 s67, 24, 0
    v_mfma_f32_16x16x32_bf16 v[72:75], v[96:99], a[84:87], v[72:75]
    ds_read_b64_tr_b16 v[150:151], v232 offset:4096
    v_mfma_f32_16x16x32_bf16 v[80:83], v[96:99], a[88:91], v[80:83]
    buffer_load_dwordx4 v217, s[44:47], s72 offen offset:2048  lds
    v_mfma_f32_16x16x32_bf16 v[84:87], v[100:103], a[88:91], v[84:87]
    v_mfma_f32_16x16x32_bf16 v[92:95], v[100:103], a[92:95], v[92:95]
    s_sub_u32 s71, s71, s67
    s_and_b32 s73, s71, 1
    s_lshr_b32 s71, s71, 1
    ds_read_b64_tr_b16 v[152:153], v229 offset:8192
    v_mfma_f32_16x16x32_bf16 v[88:91], v[96:99], a[92:95], v[88:91]
    s_add_u32 m0, s74, 101376
    v_mfma_f32_16x16x32_bf16 v[48:51], v[104:107], a[96:99], v[48:51]
    buffer_load_dwordx4 v218, s[44:47], s72 offen offset:0  lds
    v_mfma_f32_16x16x32_bf16 v[52:55], v[108:111], a[96:99], v[52:55]
    ds_read_b64_tr_b16 v[154:155], v229 offset:12288
    v_mfma_f32_16x16x32_bf16 v[60:63], v[108:111], a[100:103], v[60:63]
    s_lshl_b32 s68, s73, 7
    s_mul_i32 s73, s73, 12288
    s_add_u32 s66, s66, s73
    v_mfma_f32_16x16x32_bf16 v[56:59], v[104:107], a[100:103], v[56:59]
    ds_read_b64_tr_b16 v[156:157], v232 offset:8192
    v_mfma_f32_16x16x32_bf16 v[64:67], v[104:107], a[104:107], v[64:67]
    buffer_load_dwordx4 v219, s[44:47], s72 offen offset:1024  lds
    v_mfma_f32_16x16x32_bf16 v[68:71], v[108:111], a[104:107], v[68:71]
    ds_read_b64_tr_b16 v[158:159], v232 offset:12288
    v_mfma_f32_16x16x32_bf16 v[76:79], v[108:111], a[108:111], v[76:79]
    s_lshr_b32 s73, s71, 1
    s_mul_i32 s73, s73, 768
    s_add_u32 s66, s66, s73
    v_mfma_f32_16x16x32_bf16 v[72:75], v[104:107], a[108:111], v[72:75]
    ds_read_b64_tr_b16 v[160:161], v229 offset:16384
    v_mfma_f32_16x16x32_bf16 v[80:83], v[104:107], a[112:115], v[80:83]
    buffer_load_dwordx4 v220, s[44:47], s72 offen offset:2048  lds
    v_mfma_f32_16x16x32_bf16 v[84:87], v[108:111], a[112:115], v[84:87]
    v_mfma_f32_16x16x32_bf16 v[92:95], v[108:111], a[116:119], v[92:95]
    s_lshl_b32 s73, s71, 7
    s_add_u32 s66, s66, s73
    s_mul_i32 s73, s53, 12
    ds_read_b64_tr_b16 v[162:163], v229 offset:20480
    v_mfma_f32_16x16x32_bf16 v[88:91], v[104:107], a[116:119], v[88:91]
    s_add_u32 m0, s74, 122880
    s_add_u32 s72, s80, s84
    v_mfma_f32_16x16x32_bf16 v[48:51], v[112:115], a[120:123], v[48:51]
    buffer_load_dwordx4 v215, s[44:47], s72 offen offset:0  lds
    v_mfma_f32_16x16x32_bf16 v[52:55], v[116:119], a[120:123], v[52:55]
    ds_read_b64_tr_b16 v[164:165], v232 offset:16384
    v_mfma_f32_16x16x32_bf16 v[60:63], v[116:119], a[124:127], v[60:63]
    s_add_u32 s71, s71, s73
    s_mul_i32 s71, s71, 20480
    s_add_u32 s68, s68, s71
    v_mfma_f32_16x16x32_bf16 v[56:59], v[112:115], a[124:127], v[56:59]
    ds_read_b64_tr_b16 v[166:167], v232 offset:20480
    v_mfma_f32_16x16x32_bf16 v[64:67], v[112:115], a[128:131], v[64:67]
    buffer_load_dwordx4 v216, s[44:47], s72 offen offset:1024  lds
    v_mfma_f32_16x16x32_bf16 v[68:71], v[116:119], a[128:131], v[68:71]
    v_mfma_f32_16x16x32_bf16 v[76:79], v[116:119], a[132:135], v[76:79]
    s_mul_i32 s71, s55, 1280
    s_add_u32 s68, s68, s71
    v_mfma_f32_16x16x32_bf16 v[72:75], v[112:115], a[132:135], v[72:75]
    v_mfma_f32_16x16x32_bf16 v[80:83], v[112:115], a[136:139], v[80:83]
    buffer_load_dwordx4 v217, s[44:47], s72 offen offset:2048  lds
    v_mfma_f32_16x16x32_bf16 v[84:87], v[116:119], a[136:139], v[84:87]
    v_mfma_f32_16x16x32_bf16 v[92:95], v[116:119], a[140:143], v[92:95]
    v_mfma_f32_16x16x32_bf16 v[88:91], v[112:115], a[140:143], v[88:91]
    s_cmp_eq_u32 s1, 0
    s_waitcnt lgkmcnt(0)
    s_cbranch_scc1 L_f1
    s_waitcnt vmcnt(9) lgkmcnt(0)
    s_barrier
L_h1:
    v_mfma_f32_16x16x32_bf16 v[48:51], v[144:147], a[144:147], v[48:51]
    s_add_u32 s71, s0, 1
    v_mov_b32 v242, s71
    buffer_store_dword v242, v243, s[4:7], 0 offen
    v_mfma_f32_16x16x32_bf16 v[52:55], v[148:151], a[144:147], v[52:55]
    ds_read_b64_tr_b16 v[96:97], v230 offset:24576
    v_mfma_f32_16x16x32_bf16 v[60:63], v[148:151], a[148:151], v[60:63]
    v_lshrrev_b32 v248, 4, v240
    ds_read_b64_tr_b16 v[98:99], v230 offset:28672
    v_mfma_f32_16x16x32_bf16 v[56:59], v[144:147], a[148:151], v[56:59]
    s_add_u32 m0, s74, 125952
    v_mfma_f32_16x16x32_bf16 v[64:67], v[144:147], a[152:155], v[64:67]
    buffer_load_dwordx4 v218, s[44:47], s72 offen offset:0  lds
    v_and_b32 v249, 7, v240
    v_mfma_f32_16x16x32_bf16 v[68:71], v[148:151], a[152:155], v[68:71]
    ds_read_b64_tr_b16 v[100:101], v233 offset:24576
    v_mfma_f32_16x16x32_bf16 v[76:79], v[148:151], a[156:159], v[76:79]
    v_mfma_f32_16x16x32_bf16 v[72:75], v[144:147], a[156:159], v[72:75]
    v_bfe_u32 v251, v240, 3, 1
    ds_read_b64_tr_b16 v[102:103], v233 offset:28672
    v_mfma_f32_16x16x32_bf16 v[80:83], v[144:147], a[160:163], v[80:83]
    buffer_load_dwordx4 v219, s[44:47], s72 offen offset:1024  lds
    v_mfma_f32_16x16x32_bf16 v[84:87], v[148:151], a[160:163], v[84:87]
    v_mfma_f32_16x16x32_bf16 v[92:95], v[148:151], a[164:167], v[92:95]
    v_mul_u32_u24 v250, 6144, v251
    ds_read_b64_tr_b16 v[104:105], v230 offset:32768
    v_mfma_f32_16x16x32_bf16 v[88:91], v[144:147], a[164:167], v[88:91]
    v_mfma_f32_16x16x32_bf16 v[48:51], v[152:155], a[168:171], v[48:51]
    buffer_load_dwordx4 v220, s[44:47], s72 offen offset:2048  lds
    v_mfma_f32_16x16x32_bf16 v[52:55], v[156:159], a[168:171], v[52:55]
    v_lshl_add_u32 v250, v248, 8, v250
    ds_read_b64_tr_b16 v[106:107], v230 offset:36864
    v_mfma_f32_16x16x32_bf16 v[60:63], v[156:159], a[172:175], v[60:63]
    v_mfma_f32_16x16x32_bf16 v[56:59], v[152:155], a[172:175], v[56:59]
    s_add_u32 m0, s74, 24576
    s_add_u32 s72, s80, s85
    ds_read_b64_tr_b16 v[108:109], v233 offset:32768
    v_mfma_f32_16x16x32_bf16 v[64:67], v[152:155], a[176:179], v[64:67]
    buffer_load_dwordx4 v215, s[44:47], s72 offen offset:0  lds
    v_lshl_add_u32 v250, v249, 4, v250
    v_mfma_f32_16x16x32_bf16 v[68:71], v[156:159], a[176:179], v[68:71]
    ds_read_b64_tr_b16 v[110:111], v233 offset:36864
    v_mfma_f32_16x16x32_bf16 v[76:79], v[156:159], a[180:183], v[76:79]
    v_mfma_f32_16x16x32_bf16 v[72:75], v[152:155], a[180:183], v[72:75]
    v_add_u32 v223, s66, v250
    ds_read_b64_tr_b16 v[112:113], v230 offset:40960
    v_mfma_f32_16x16x32_bf16 v[80:83], v[152:155], a[184:187], v[80:83]
    buffer_load_dwordx4 v216, s[44:47], s72 offen offset:1024  lds
    v_mfma_f32_16x16x32_bf16 v[84:87], v[156:159], a[184:187], v[84:87]
    v_mfma_f32_16x16x32_bf16 v[92:95], v[156:159], a[188:191], v[92:95]
    v_mul_u32_u24 v250, 2560, v249
    ds_read_b64_tr_b16 v[114:115], v230 offset:45056
    v_mfma_f32_16x16x32_bf16 v[88:91], v[152:155], a[188:191], v[88:91]
    v_mfma_f32_16x16x32_bf16 v[48:51], v[160:163], a[192:195], v[48:51]
    buffer_load_dwordx4 v217, s[44:47], s72 offen offset:2048  lds
    v_mfma_f32_16x16x32_bf16 v[52:55], v[164:167], a[192:195], v[52:55]
    v_lshl_add_u32 v250, v251, 6, v250
    ds_read_b64_tr_b16 v[116:117], v233 offset:40960
    v_mfma_f32_16x16x32_bf16 v[60:63], v[164:167], a[196:199], v[60:63]
    v_mfma_f32_16x16x32_bf16 v[56:59], v[160:163], a[196:199], v[56:59]
    s_add_u32 m0, s74, 27648
    ds_read_b64_tr_b16 v[118:119], v233 offset:45056
    v_mfma_f32_16x16x32_bf16 v[64:67], v[160:163], a[200:203], v[64:67]
    buffer_load_dwordx4 v218, s[44:47], s72 offen offset:0  lds
    v_lshl_add_u32 v250, v248, 4, v250
    v_mfma_f32_16x16x32_bf16 v[68:71], v[164:167], a[200:203], v[68:71]
    v_mfma_f32_16x16x32_bf16 v[76:79], v[164:167], a[204:207], v[76:79]
    v_mfma_f32_16x16x32_bf16 v[72:75], v[160:163], a[204:207], v[72:75]
    v_add_u32 v214, s68, v250
    v_mfma_f32_16x16x32_bf16 v[80:83], v[160:163], a[208:211], v[80:83]
    buffer_load_dwordx4 v219, s[44:47], s72 offen offset:1024  lds
    v_mfma_f32_16x16x32_bf16 v[84:87], v[164:167], a[208:211], v[84:87]
    v_mfma_f32_16x16x32_bf16 v[92:95], v[164:167], a[212:215], v[92:95]
    v_mfma_f32_16x16x32_bf16 v[88:91], v[160:163], a[212:215], v[88:91]
    s_waitcnt vmcnt(12) lgkmcnt(0)
    s_barrier
    v_mfma_f32_16x16x32_bf16 v[48:51], v[96:99], a[216:219], v[48:51]
    buffer_load_dwordx4 v220, s[44:47], s72 offen offset:2048  lds
    v_mfma_f32_16x16x32_bf16 v[52:55], v[100:103], a[216:219], v[52:55]
    ds_read_b64_tr_b16 v[144:145], v231 offset:0
    v_mfma_f32_16x16x32_bf16 v[60:63], v[100:103], a[220:223], v[60:63]
    v_and_b32 v251, 1, v240
    ds_read_b64_tr_b16 v[146:147], v231 offset:4096
    v_mfma_f32_16x16x32_bf16 v[56:59], v[96:99], a[220:223], v[56:59]
    s_add_u32 m0, s74, 49152
    s_add_u32 s72, s80, s86
    v_mfma_f32_16x16x32_bf16 v[64:67], v[96:99], a[224:227], v[64:67]
    buffer_load_dwordx4 v215, s[44:47], s72 offen offset:0  lds
    v_mfma_f32_16x16x32_bf16 v[68:71], v[100:103], a[224:227], v[68:71]
    v_lshlrev_b32 v251, 4, v251
    ds_read_b64_tr_b16 v[148:149], v234 offset:0
    v_mfma_f32_16x16x32_bf16 v[76:79], v[100:103], a[228:231], v[76:79]
    v_mfma_f32_16x16x32_bf16 v[72:75], v[96:99], a[228:231], v[72:75]
    ds_read_b64_tr_b16 v[150:151], v234 offset:4096
    v_mfma_f32_16x16x32_bf16 v[80:83], v[96:99], a[232:235], v[80:83]
    buffer_load_dwordx4 v216, s[44:47], s72 offen offset:1024  lds
    v_mfma_f32_16x16x32_bf16 v[84:87], v[100:103], a[232:235], v[84:87]
    v_mov_b32 v250, 0x3f80
    v_mfma_f32_16x16x32_bf16 v[92:95], v[100:103], a[236:239], v[92:95]
    ds_read_b64_tr_b16 v[152:153], v231 offset:8192
    v_mfma_f32_16x16x32_bf16 v[88:91], v[96:99], a[236:239], v[88:91]
    v_mfma_f32_16x16x32_bf16 v[48:51], v[104:107], a[240:243], v[48:51]
    buffer_load_dwordx4 v217, s[44:47], s72 offen offset:2048  lds
    v_lshlrev_b32 v250, v251, v250
    v_mfma_f32_16x16x32_bf16 v[52:55], v[108:111], a[240:243], v[52:55]
    ds_read_b64_tr_b16 v[154:155], v231 offset:12288
    v_mfma_f32_16x16x32_bf16 v[60:63], v[108:111], a[244:247], v[60:63]
    v_mfma_f32_16x16x32_bf16 v[56:59], v[104:107], a[244:247], v[56:59]
    s_add_u32 m0, s74, 52224
    ds_read_b64_tr_b16 v[156:157], v234 offset:8192
    v_mfma_f32_16x16x32_bf16 v[64:67], v[104:107], a[248:251], v[64:67]
    buffer_load_dwordx4 v218, s[44:47], s72 offen offset:0  lds
    v_bfe_u32 v249, v240, 1, 3
    v_mfma_f32_16x16x32_bf16 v[68:71], v[108:111], a[248:251], v[68:71]
    ds_read_b64_tr_b16 v[158:159], v234 offset:12288
    v_mfma_f32_16x16x32_bf16 v[76:79], v[108:111], a[252:255], v[76:79]
    v_mfma_f32_16x16x32_bf16 v[72:75], v[104:107], a[252:255], v[72:75]
    v_lshlrev_b32 v248, 1, v248
    ds_read_b64_tr_b16 v[160:161], v231 offset:16384
    v_mfma_f32_16x16x32_bf16 v[80:83], v[104:107], v[168:171], v[80:83]
    buffer_load_dwordx4 v219, s[44:47], s72 offen offset:1024  lds
    v_mfma_f32_16x16x32_bf16 v[84:87], v[108:111], v[168:171], v[84:87]
    v_mfma_f32_16x16x32_bf16 v[92:95], v[108:111], v[172:175], v[92:95]
    ds_read_b64_tr_b16 v[162:163], v231 offset:20480
    v_mfma_f32_16x16x32_bf16 v[88:91], v[104:107], v[172:175], v[88:91]
    v_cmp_eq_u32 vcc, v248, v249
    v_mfma_f32_16x16x32_bf16 v[48:51], v[112:115], v[176:179], v[48:51]
    buffer_load_dwordx4 v220, s[44:47], s72 offen offset:2048  lds
    v_mfma_f32_16x16x32_bf16 v[52:55], v[116:119], v[176:179], v[52:55]
    ds_read_b64_tr_b16 v[164:165], v234 offset:16384
    v_mfma_f32_16x16x32_bf16 v[60:63], v[116:119], v[180:183], v[60:63]
    v_add_u32 v248, 1, v248
    v_mfma_f32_16x16x32_bf16 v[56:59], v[112:115], v[180:183], v[56:59]
    s_mov_b32 m0, s74
    s_add_u32 s72, s81, s83
    ds_read_b64_tr_b16 v[166:167], v234 offset:20480
    v_mfma_f32_16x16x32_bf16 v[64:67], v[112:115], v[184:187], v[64:67]
    buffer_load_dwordx4 v215, s[44:47], s72 offen offset:0  lds
    v_mfma_f32_16x16x32_bf16 v[68:71], v[116:119], v[184:187], v[68:71]
    v_mfma_f32_16x16x32_bf16 v[76:79], v[116:119], v[188:191], v[76:79]
    v_cndmask_b32 v202, 0, v250, vcc
    v_mfma_f32_16x16x32_bf16 v[72:75], v[112:115], v[188:191], v[72:75]
    v_mfma_f32_16x16x32_bf16 v[80:83], v[112:115], v[192:195], v[80:83]
    buffer_load_dwordx4 v216, s[44:47], s72 offen offset:1024  lds
    v_mfma_f32_16x16x32_bf16 v[84:87], v[116:119], v[192:195], v[84:87]
    v_mfma_f32_16x16x32_bf16 v[92:95], v[116:119], v[196:199], v[92:95]
    v_mfma_f32_16x16x32_bf16 v[88:91], v[112:115], v[196:199], v[88:91]
    s_waitcnt vmcnt(14) lgkmcnt(0)
    s_barrier
    v_mfma_f32_16x16x32_bf16 v[0:3], v[144:147], a[0:3], 0
    buffer_load_dwordx4 v217, s[44:47], s72 offen offset:2048  lds
    v_mfma_f32_16x16x32_bf16 v[4:7], v[148:151], a[0:3], 0
    ds_read_b64_tr_b16 v[96:97], v231 offset:24576
    v_mfma_f32_16x16x32_bf16 v[12:15], v[148:151], a[4:7], 0
    ds_read_b64_tr_b16 v[98:99], v231 offset:28672
    v_mfma_f32_16x16x32_bf16 v[8:11], v[144:147], a[4:7], 0
    s_add_u32 m0, s74, 3072
    v_mfma_f32_16x16x32_bf16 v[16:19], v[144:147], a[8:11], 0
    buffer_load_dwordx4 v218, s[44:47], s72 offen offset:0  lds
    v_mfma_f32_16x16x32_bf16 v[20:23], v[148:151], a[8:11], 0
    ds_read_b64_tr_b16 v[100:101], v234 offset:24576
    v_mfma_f32_16x16x32_bf16 v[28:31], v[148:151], a[12:15], 0
    v_mfma_f32_16x16x32_bf16 v[24:27], v[144:147], a[12:15], 0
    ds_read_b64_tr_b16 v[102:103], v234 offset:28672
    v_mfma_f32_16x16x32_bf16 v[32:35], v[144:147], a[16:19], 0
    buffer_load_dwordx4 v219, s[44:47], s72 offen offset:1024  lds
    v_cvt_pk_bf16_f32 v48, v48, v49
    v_mfma_f32_16x16x32_bf16 v[36:39], v[148:151], a[16:19], 0
    v_cvt_pk_bf16_f32 v49, v50, v51
    v_mfma_f32_16x16x32_bf16 v[44:47], v[148:151], a[20:23], 0
    v_cvt_pk_bf16_f32 v50, v52, v53
    ds_read_b64_tr_b16 v[104:105], v231 offset:32768
    v_mfma_f32_16x16x32_bf16 v[40:43], v[144:147], a[20:23], 0
    v_cvt_pk_bf16_f32 v51, v54, v55
    v_mfma_f32_16x16x32_bf16 v[0:3], v[152:155], a[24:27], v[0:3]
    buffer_store_dwordx4 v[48:51], v238, s[28:31], s58 offen offset:0
    v_cvt_pk_bf16_f32 v56, v56, v57
    v_mfma_f32_16x16x32_bf16 v[4:7], v[156:159], a[24:27], v[4:7]
    v_cvt_pk_bf16_f32 v57, v58, v59
    ds_read_b64_tr_b16 v[106:107], v231 offset:36864
    v_mfma_f32_16x16x32_bf16 v[12:15], v[156:159], a[28:31], v[12:15]
    v_cvt_pk_bf16_f32 v58, v60, v61
    v_mfma_f32_16x16x32_bf16 v[8:11], v[152:155], a[28:31], v[8:11]
    v_cvt_pk_bf16_f32 v59, v62, v63
    ds_read_b64_tr_b16 v[108:109], v234 offset:32768
    v_mfma_f32_16x16x32_bf16 v[16:19], v[152:155], a[32:35], v[16:19]
    buffer_store_dwordx4 v[56:59], v238, s[28:31], s58 offen offset:1024
    v_cvt_pk_bf16_f32 v64, v64, v65
    v_mfma_f32_16x16x32_bf16 v[20:23], v[156:159], a[32:35], v[20:23]
    v_cvt_pk_bf16_f32 v65, v66, v67
    ds_read_b64_tr_b16 v[110:111], v234 offset:36864
    v_mfma_f32_16x16x32_bf16 v[28:31], v[156:159], a[36:39], v[28:31]
    v_cvt_pk_bf16_f32 v66, v68, v69
    v_mfma_f32_16x16x32_bf16 v[24:27], v[152:155], a[36:39], v[24:27]
    v_cvt_pk_bf16_f32 v67, v70, v71
    ds_read_b64_tr_b16 v[112:113], v231 offset:40960
    v_mfma_f32_16x16x32_bf16 v[32:35], v[152:155], a[40:43], v[32:35]
    buffer_store_dwordx4 v[64:67], v238, s[28:31], s58 offen offset:2048
    v_cvt_pk_bf16_f32 v72, v72, v73
    v_mfma_f32_16x16x32_bf16 v[36:39], v[156:159], a[40:43], v[36:39]
    v_cvt_pk_bf16_f32 v73, v74, v75
    v_mfma_f32_16x16x32_bf16 v[44:47], v[156:159], a[44:47], v[44:47]
    v_cvt_pk_bf16_f32 v74, v76, v77
    ds_read_b64_tr_b16 v[114:115], v231 offset:45056
    v_mfma_f32_16x16x32_bf16 v[40:43], v[152:155], a[44:47], v[40:43]
    v_cvt_pk_bf16_f32 v75, v78, v79
    v_mfma_f32_16x16x32_bf16 v[0:3], v[160:163], a[48:51], v[0:3]
    buffer_store_dwordx4 v[72:75], v239, s[28:31], s58 offen offset:0
    v_cvt_pk_bf16_f32 v80, v80, v81
    v_mfma_f32_16x16x32_bf16 v[4:7], v[164:167], a[48:51], v[4:7]
    v_cvt_pk_bf16_f32 v81, v82, v83
    ds_read_b64_tr_b16 v[116:117], v234 offset:40960
    v_mfma_f32_16x16x32_bf16 v[12:15], v[164:167], a[52:55], v[12:15]
    v_cvt_pk_bf16_f32 v82, v84, v85
    v_mfma_f32_16x16x32_bf16 v[8:11], v[160:163], a[52:55], v[8:11]
    v_cvt_pk_bf16_f32 v83, v86, v87
    ds_read_b64_tr_b16 v[118:119], v234 offset:45056
    v_mfma_f32_16x16x32_bf16 v[16:19], v[160:163], a[56:59], v[16:19]
    buffer_store_dwordx4 v[80:83], v239, s[28:31], s58 offen offset:1024
    v_cvt_pk_bf16_f32 v88, v88, v89
    v_mfma_f32_16x16x32_bf16 v[20:23], v[164:167], a[56:59], v[20:23]
    v_cvt_pk_bf16_f32 v89, v90, v91
    v_mfma_f32_16x16x32_bf16 v[28:31], v[164:167], a[60:63], v[28:31]
    v_cvt_pk_bf16_f32 v90, v92, v93
    v_mfma_f32_16x16x32_bf16 v[24:27], v[160:163], a[60:63], v[24:27]
    v_cvt_pk_bf16_f32 v91, v94, v95
    v_mfma_f32_16x16x32_bf16 v[32:35], v[160:163], a[64:67], v[32:35]
    buffer_store_dwordx4 v[88:91], v239, s[28:31], s58 offen offset:2048
    v_mfma_f32_16x16x32_bf16 v[36:39], v[164:167], a[64:67], v[36:39]
    v_mfma_f32_16x16x32_bf16 v[44:47], v[164:167], a[68:71], v[44:47]
    v_mfma_f32_16x16x32_bf16 v[40:43], v[160:163], a[68:71], v[40:43]
    s_waitcnt vmcnt(17) lgkmcnt(0)
    s_barrier
    v_mfma_f32_16x16x32_bf16 v[0:3], v[96:99], a[72:75], v[0:3]
    buffer_load_dword v244, off, s[8:11], s64 sc1
    v_mfma_f32_16x16x32_bf16 v[4:7], v[100:103], a[72:75], v[4:7]
    ds_read_b64_tr_b16 v[144:145], v229 offset:24576
    v_mfma_f32_16x16x32_bf16 v[12:15], v[100:103], a[76:79], v[12:15]
    v_cmp_eq_u32 vcc, v248, v249
    ds_read_b64_tr_b16 v[146:147], v229 offset:28672
    v_mfma_f32_16x16x32_bf16 v[8:11], v[96:99], a[76:79], v[8:11]
    v_mfma_f32_16x16x32_bf16 v[16:19], v[96:99], a[80:83], v[16:19]
    buffer_load_dwordx4 v220, s[44:47], s72 offen offset:2048  lds
    v_mfma_f32_16x16x32_bf16 v[20:23], v[100:103], a[80:83], v[20:23]
    ds_read_b64_tr_b16 v[148:149], v232 offset:24576
    v_mfma_f32_16x16x32_bf16 v[28:31], v[100:103], a[84:87], v[28:31]
    v_mfma_f32_16x16x32_bf16 v[24:27], v[96:99], a[84:87], v[24:27]
    s_add_u32 m0, s74, 73728
    s_add_u32 s72, s81, s84
    v_mov_b32 v200, 0
    ds_read_b64_tr_b16 v[150:151], v232 offset:28672
    v_mfma_f32_16x16x32_bf16 v[32:35], v[96:99], a[88:91], v[32:35]
    buffer_load_dwordx4 v215, s[44:47], s72 offen offset:0  lds
    v_mfma_f32_16x16x32_bf16 v[36:39], v[100:103], a[88:91], v[36:39]
    v_mfma_f32_16x16x32_bf16 v[44:47], v[100:103], a[92:95], v[44:47]
    ds_read_b64_tr_b16 v[152:153], v229 offset:32768
    v_mfma_f32_16x16x32_bf16 v[40:43], v[96:99], a[92:95], v[40:43]
    v_mfma_f32_16x16x32_bf16 v[0:3], v[104:107], a[96:99], v[0:3]
    buffer_load_dwordx4 v216, s[44:47], s72 offen offset:1024  lds
    v_cndmask_b32 v203, 0, v250, vcc
    v_mfma_f32_16x16x32_bf16 v[4:7], v[108:111], a[96:99], v[4:7]
    ds_read_b64_tr_b16 v[154:155], v229 offset:36864
    v_mfma_f32_16x16x32_bf16 v[12:15], v[108:111], a[100:103], v[12:15]
    v_mfma_f32_16x16x32_bf16 v[8:11], v[104:107], a[100:103], v[8:11]
    ds_read_b64_tr_b16 v[156:157], v232 offset:32768
    v_mfma_f32_16x16x32_bf16 v[16:19], v[104:107], a[104:107], v[16:19]
    buffer_load_dwordx4 v217, s[44:47], s72 offen offset:2048  lds
    v_mfma_f32_16x16x32_bf16 v[20:23], v[108:111], a[104:107], v[20:23]
    ds_read_b64_tr_b16 v[158:159], v232 offset:36864
    v_mfma_f32_16x16x32_bf16 v[28:31], v[108:111], a[108:111], v[28:31]
    v_mov_b32 v201, 0
    v_mfma_f32_16x16x32_bf16 v[24:27], v[104:107], a[108:111], v[24:27]
    s_add_u32 m0, s74, 76800
    ds_read_b64_tr_b16 v[160:161], v229 offset:40960
    v_mfma_f32_16x16x32_bf16 v[32:35], v[104:107], a[112:115], v[32:35]
    buffer_load_dwordx4 v218, s[44:47], s72 offen offset:0  lds
    v_mfma_f32_16x16x32_bf16 v[36:39], v[108:111], a[112:115], v[36:39]
    v_mfma_f32_16x16x32_bf16 v[44:47], v[108:111], a[116:119], v[44:47]
    ds_read_b64_tr_b16 v[162:163], v229 offset:45056
    v_mfma_f32_16x16x32_bf16 v[40:43], v[104:107], a[116:119], v[40:43]
    v_mov_b32 v204, 0
    v_mfma_f32_16x16x32_bf16 v[0:3], v[112:115], a[120:123], v[0:3]
    buffer_load_dwordx4 v219, s[44:47], s72 offen offset:1024  lds
    v_mfma_f32_16x16x32_bf16 v[4:7], v[116:119], a[120:123], v[4:7]
    ds_read_b64_tr_b16 v[164:165], v232 offset:40960
    v_mfma_f32_16x16x32_bf16 v[12:15], v[116:119], a[124:127], v[12:15]
    v_mfma_f32_16x16x32_bf16 v[8:11], v[112:115], a[124:127], v[8:11]
    ds_read_b64_tr_b16 v[166:167], v232 offset:45056
    v_mfma_f32_16x16x32_bf16 v[16:19], v[112:115], a[128:131], v[16:19]
    buffer_load_dwordx4 v220, s[44:47], s72 offen offset:2048  lds
    v_mov_b32 v205, 0
    v_mfma_f32_16x16x32_bf16 v[20:23], v[116:119], a[128:131], v[20:23]
    v_mfma_f32_16x16x32_bf16 v[28:31], v[116:119], a[132:135], v[28:31]
    v_mfma_f32_16x16x32_bf16 v[24:27], v[112:115], a[132:135], v[24:27]
    s_add_u32 m0, s74, 98304
    s_add_u32 s72, s81, s85
    v_mfma_f32_16x16x32_bf16 v[32:35], v[112:115], a[136:139], v[32:35]
    buffer_load_dwordx4 v215, s[44:47], s72 offen offset:0  lds
    v_mfma_f32_16x16x32_bf16 v[36:39], v[116:119], a[136:139], v[36:39]
    v_mfma_f32_16x16x32_bf16 v[44:47], v[116:119], a[140:143], v[44:47]
    v_mfma_f32_16x16x32_bf16 v[40:43], v[112:115], a[140:143], v[40:43]
    s_cmp_eq_u32 s1, 0
    s_waitcnt lgkmcnt(0)
    s_cbranch_scc1 L_f2
    s_waitcnt vmcnt(8) lgkmcnt(0)
    s_barrier
L_h2:
L_c1:
    v_readfirstlane_b32 s71, v244
    s_nop 0
    s_and_b32 s71, s71, 0xff
    s_cmp_ge_u32 s71, 1
    s_cbranch_scc0 L_s1
L_k1:
    v_mfma_f32_16x16x32_bf16 v[0:3], v[144:147], a[144:147], v[0:3]
    buffer_load_dwordx4 v[120:123], v238, s[28:31], s59 offen offset:0 sc1
    v_mfma_f32_16x16x32_bf16 v[4:7], v[148:151], a[144:147], v[4:7]
    ds_read_b64_tr_b16 v[96:97], v230 offset:0
    v_mfma_f32_16x16x32_bf16 v[12:15], v[148:151], a[148:151], v[12:15]
    ds_read_b64_tr_b16 v[98:99], v230 offset:4096
    v_mfma_f32_16x16x32_bf16 v[8:11], v[144:147], a[148:151], v[8:11]
    v_mfma_f32_16x16x32_bf16 v[16:19], v[144:147], a[152:155], v[16:19]
    buffer_load_dwordx4 v[124:127], v238, s[28:31], s59 offen offset:1024 sc1
    v_mfma_f32_16x16x32_bf16 v[20:23], v[148:151], a[152:155], v[20:23]
    ds_read_b64_tr_b16 v[100:101], v233 offset:0
    v_mfma_f32_16x16x32_bf16 v[28:31], v[148:151], a[156:159], v[28:31]
    v_mfma_f32_16x16x32_bf16 v[24:27], v[144:147], a[156:159], v[24:27]
    ds_read_b64_tr_b16 v[102:103], v233 offset:4096
    v_mfma_f32_16x16x32_bf16 v[32:35], v[144:147], a[160:163], v[32:35]
    buffer_load_dwordx4 v[128:131], v238, s[28:31], s59 offen offset:2048 sc1
    v_mfma_f32_16x16x32_bf16 v[36:39], v[148:151], a[160:163], v[36:39]
    v_mfma_f32_16x16x32_bf16 v[44:47], v[148:151], a[164:167], v[44:47]
    ds_read_b64_tr_b16 v[104:105], v230 offset:8192
    v_mfma_f32_16x16x32_bf16 v[40:43], v[144:147], a[164:167], v[40:43]
    v_mfma_f32_16x16x32_bf16 v[0:3], v[152:155], a[168:171], v[0:3]
    buffer_load_dwordx4 v[132:135], v239, s[28:31], s59 offen offset:0 sc1
    v_mfma_f32_16x16x32_bf16 v[4:7], v[156:159], a[168:171], v[4:7]
    ds_read_b64_tr_b16 v[106:107], v230 offset:12288
    v_mfma_f32_16x16x32_bf16 v[12:15], v[156:159], a[172:175], v[12:15]
    v_mfma_f32_16x16x32_bf16 v[8:11], v[152:155], a[172:175], v[8:11]
    ds_read_b64_tr_b16 v[108:109], v233 offset:8192
    v_mfma_f32_16x16x32_bf16 v[16:19], v[152:155], a[176:179], v[16:19]
    buffer_load_dwordx4 v[136:139], v239, s[28:31], s59 offen offset:1024 sc1
    v_mfma_f32_16x16x32_bf16 v[20:23], v[156:159], a[176:179], v[20:23]
    ds_read_b64_tr_b16 v[110:111], v233 offset:12288
    v_mfma_f32_16x16x32_bf16 v[28:31], v[156:159], a[180:183], v[28:31]
    v_mfma_f32_16x16x32_bf16 v[24:27], v[152:155], a[180:183], v[24:27]
    ds_read_b64_tr_b16 v[112:113], v230 offset:16384
    v_mfma_f32_16x16x32_bf16 v[32:35], v[152:155], a[184:187], v[32:35]
    buffer_load_dwordx4 v[140:143], v239, s[28:31], s59 offen offset:2048 sc1
    v_mfma_f32_16x16x32_bf16 v[36:39], v[156:159], a[184:187], v[36:39]
    v_mfma_f32_16x16x32_bf16 v[44:47], v[156:159], a[188:191], v[44:47]
    ds_read_b64_tr_b16 v[114:115], v230 offset:20480
    v_mfma_f32_16x16x32_bf16 v[40:43], v[152:155], a[188:191], v[40:43]
    s_add_u32 s71, s0, 2
    v_mov_b32 v242, s71
    v_mfma_f32_16x16x32_bf16 v[0:3], v[160:163], a[192:195], v[0:3]
    buffer_store_dword v242, v243, s[4:7], 0 offen
    v_mfma_f32_16x16x32_bf16 v[4:7], v[164:167], a[192:195], v[4:7]
    ds_read_b64_tr_b16 v[116:117], v233 offset:16384
    v_mfma_f32_16x16x32_bf16 v[12:15], v[164:167], a[196:199], v[12:15]
    v_mfma_f32_16x16x32_bf16 v[8:11], v[160:163], a[196:199], v[8:11]
    ds_read_b64_tr_b16 v[118:119], v233 offset:20480
    v_mfma_f32_16x16x32_bf16 v[16:19], v[160:163], a[200:203], v[16:19]
    buffer_load_dwordx4 v216, s[44:47], s72 offen offset:1024  lds
    v_mfma_f32_16x16x32_bf16 v[20:23], v[164:167], a[200:203], v[20:23]
    v_mfma_f32_16x16x32_bf16 v[28:31], v[164:167], a[204:207], v[28:31]
    v_mfma_f32_16x16x32_bf16 v[24:27], v[160:163], a[204:207], v[24:27]
    v_mfma_f32_16x16x32_bf16 v[32:35], v[160:163], a[208:211], v[32:35]
    buffer_load_dwordx4 v217, s[44:47], s72 offen offset:2048  lds
    v_mfma_f32_16x16x32_bf16 v[36:39], v[164:167], a[208:211], v[36:39]
    v_mfma_f32_16x16x32_bf16 v[44:47], v[164:167], a[212:215], v[44:47]
    v_mfma_f32_16x16x32_bf16 v[40:43], v[160:163], a[212:215], v[40:43]
    s_waitcnt vmcnt(16) lgkmcnt(0)
    s_barrier
    v_mfma_f32_16x16x32_bf16 v[0:3], v[96:99], a[216:219], v[0:3]
    s_add_u32 m0, s74, 101376
    s_nop 0
    buffer_load_dwordx4 v218, s[44:47], s72 offen offset:0  lds
    v_mfma_f32_16x16x32_bf16 v[4:7], v[100:103], a[216:219], v[4:7]
    ds_read_b64_tr_b16 v[144:145], v229 offset:0
    v_mfma_f32_16x16x32_bf16 v[12:15], v[100:103], a[220:223], v[12:15]
    ds_read_b64_tr_b16 v[146:147], v229 offset:4096
    v_mfma_f32_16x16x32_bf16 v[8:11], v[96:99], a[220:223], v[8:11]
    v_mfma_f32_16x16x32_bf16 v[16:19], v[96:99], a[224:227], v[16:19]
    buffer_load_dwordx4 v219, s[44:47], s72 offen offset:1024  lds
    v_mfma_f32_16x16x32_bf16 v[20:23], v[100:103], a[224:227], v[20:23]
    ds_read_b64_tr_b16 v[148:149], v232 offset:0
    v_mfma_f32_16x16x32_bf16 v[28:31], v[100:103], a[228:231], v[28:31]
    v_mfma_f32_16x16x32_bf16 v[24:27], v[96:99], a[228:231], v[24:27]
    ds_read_b64_tr_b16 v[150:151], v232 offset:4096
    v_mfma_f32_16x16x32_bf16 v[32:35], v[96:99], a[232:235], v[32:35]
    buffer_load_dwordx4 v220, s[44:47], s72 offen offset:2048  lds
    v_mfma_f32_16x16x32_bf16 v[36:39], v[100:103], a[232:235], v[36:39]
    v_mfma_f32_16x16x32_bf16 v[44:47], v[100:103], a[236:239], v[44:47]
    ds_read_b64_tr_b16 v[152:153], v229 offset:8192
    v_mfma_f32_16x16x32_bf16 v[40:43], v[96:99], a[236:239], v[40:43]
    s_add_u32 m0, s74, 122880
    s_add_u32 s72, s81, s86
    v_mfma_f32_16x16x32_bf16 v[0:3], v[104:107], a[240:243], v[0:3]
    buffer_load_dwordx4 v215, s[44:47], s72 offen offset:0  lds
    v_mfma_f32_16x16x32_bf16 v[4:7], v[108:111], a[240:243], v[4:7]
    s_waitcnt vmcnt(12)
    v_mfma_f32_16x16x32_bf16 v[0:3], v[202:205], v[120:123], v[0:3]
    v_mfma_f32_16x16x32_bf16 v[4:7], v[200:203], v[120:123], v[4:7]
    ds_read_b64_tr_b16 v[154:155], v229 offset:12288
    v_mfma_f32_16x16x32_bf16 v[12:15], v[108:111], a[244:247], v[12:15]
    v_mfma_f32_16x16x32_bf16 v[8:11], v[104:107], a[244:247], v[8:11]
    ds_read_b64_tr_b16 v[156:157], v232 offset:8192
    v_mfma_f32_16x16x32_bf16 v[16:19], v[104:107], a[248:251], v[16:19]
    buffer_load_dwordx4 v216, s[44:47], s72 offen offset:1024  lds
    v_mfma_f32_16x16x32_bf16 v[20:23], v[108:111], a[248:251], v[20:23]
    s_waitcnt vmcnt(12)
    v_mfma_f32_16x16x32_bf16 v[8:11], v[202:205], v[124:127], v[8:11]
    v_mfma_f32_16x16x32_bf16 v[12:15], v[200:203], v[124:127], v[12:15]
    ds_read_b64_tr_b16 v[158:159], v232 offset:12288
    v_mfma_f32_16x16x32_bf16 v[28:31], v[108:111], a[252:255], v[28:31]
    v_mfma_f32_16x16x32_bf16 v[24:27], v[104:107], a[252:255], v[24:27]
    ds_read_b64_tr_b16 v[160:161], v229 offset:16384
    v_mfma_f32_16x16x32_bf16 v[32:35], v[104:107], v[168:171], v[32:35]
    buffer_load_dwordx4 v217, s[44:47], s72 offen offset:2048  lds
    v_mfma_f32_16x16x32_bf16 v[36:39], v[108:111], v[168:171], v[36:39]
    s_waitcnt vmcnt(12)
    v_mfma_f32_16x16x32_bf16 v[16:19], v[202:205], v[128:131], v[16:19]
    v_mfma_f32_16x16x32_bf16 v[20:23], v[200:203], v[128:131], v[20:23]
    v_mfma_f32_16x16x32_bf16 v[44:47], v[108:111], v[172:175], v[44:47]
    ds_read_b64_tr_b16 v[162:163], v229 offset:20480
    v_mfma_f32_16x16x32_bf16 v[40:43], v[104:107], v[172:175], v[40:43]
    s_add_u32 m0, s74, 125952
    v_mfma_f32_16x16x32_bf16 v[0:3], v[112:115], v[176:179], v[0:3]
    buffer_load_dwordx4 v218, s[44:47], s72 offen offset:0  lds
    v_mfma_f32_16x16x32_bf16 v[4:7], v[116:119], v[176:179], v[4:7]
    s_waitcnt vmcnt(12)
    v_mfma_f32_16x16x32_bf16 v[24:27], v[202:205], v[132:135], v[24:27]
    v_mfma_f32_16x16x32_bf16 v[28:31], v[200:203], v[132:135], v[28:31]
    ds_read_b64_tr_b16 v[164:165], v232 offset:16384
    v_mfma_f32_16x16x32_bf16 v[12:15], v[116:119], v[180:183], v[12:15]
    v_mfma_f32_16x16x32_bf16 v[8:11], v[112:115], v[180:183], v[8:11]
    ds_read_b64_tr_b16 v[166:167], v232 offset:20480
    v_mfma_f32_16x16x32_bf16 v[16:19], v[112:115], v[184:187], v[16:19]
    buffer_load_dwordx4 v219, s[44:47], s72 offen offset:1024  lds
    v_mfma_f32_16x16x32_bf16 v[20:23], v[116:119], v[184:187], v[20:23]
    s_waitcnt vmcnt(12)
    v_mfma_f32_16x16x32_bf16 v[32:35], v[202:205], v[136:139], v[32:35]
    v_mfma_f32_16x16x32_bf16 v[36:39], v[200:203], v[136:139], v[36:39]
    v_mfma_f32_16x16x32_bf16 v[28:31], v[116:119], v[188:191], v[28:31]
    v_mfma_f32_16x16x32_bf16 v[24:27], v[112:115], v[188:191], v[24:27]
    v_mfma_f32_16x16x32_bf16 v[32:35], v[112:115], v[192:195], v[32:35]
    buffer_load_dwordx4 v220, s[44:47], s72 offen offset:2048  lds
    v_mfma_f32_16x16x32_bf16 v[36:39], v[116:119], v[192:195], v[36:39]
    s_waitcnt vmcnt(12)
    v_mfma_f32_16x16x32_bf16 v[40:43], v[202:205], v[140:143], v[40:43]
    v_mfma_f32_16x16x32_bf16 v[44:47], v[200:203], v[140:143], v[44:47]
    v_mfma_f32_16x16x32_bf16 v[44:47], v[116:119], v[196:199], v[44:47]
    v_mfma_f32_16x16x32_bf16 v[40:43], v[112:115], v[196:199], v[40:43]
    s_waitcnt vmcnt(12) lgkmcnt(0)
    s_barrier
    v_mfma_f32_16x16x32_bf16 v[48:51], v[144:147], a[0:3], 0
    s_add_u32 m0, s74, 24576
    s_add_u32 s72, s82, s83
    buffer_load_dwordx4 v215, s[44:47], s72 offen offset:0  lds
    v_mfma_f32_16x16x32_bf16 v[52:55], v[148:151], a[0:3], 0
    ds_read_b64_tr_b16 v[96:97], v230 offset:24576
    v_mfma_f32_16x16x32_bf16 v[60:63], v[148:151], a[4:7], 0
    ds_read_b64_tr_b16 v[98:99], v230 offset:28672
    v_mfma_f32_16x16x32_bf16 v[56:59], v[144:147], a[4:7], 0
    v_mfma_f32_16x16x32_bf16 v[64:67], v[144:147], a[8:11], 0
    buffer_load_dwordx4 v216, s[44:47], s72 offen offset:1024  lds
    v_mfma_f32_16x16x32_bf16 v[68:71], v[148:151], a[8:11], 0
    ds_read_b64_tr_b16 v[100:101], v233 offset:24576
    v_mfma_f32_16x16x32_bf16 v[76:79], v[148:151], a[12:15], 0
    v_mfma_f32_16x16x32_bf16 v[72:75], v[144:147], a[12:15], 0
    ds_read_b64_tr_b16 v[102:103], v233 offset:28672
    v_mfma_f32_16x16x32_bf16 v[80:83], v[144:147], a[16:19], 0
    buffer_load_dwordx4 v217, s[44:47], s72 offen offset:2048  lds
    v_cvt_pk_bf16_f32 v0, v0, v1
    v_mfma_f32_16x16x32_bf16 v[84:87], v[148:151], a[16:19], 0
    v_cvt_pk_bf16_f32 v1, v2, v3
    v_mfma_f32_16x16x32_bf16 v[92:95], v[148:151], a[20:23], 0
    v_cvt_pk_bf16_f32 v2, v4, v5
    ds_read_b64_tr_b16 v[104:105], v230 offset:32768
    v_mfma_f32_16x16x32_bf16 v[88:91], v[144:147], a[20:23], 0
    v_cvt_pk_bf16_f32 v3, v6, v7
    v_mfma_f32_16x16x32_bf16 v[48:51], v[152:155], a[24:27], v[48:51]
    buffer_store_dwordx4 v[0:3], v238, s[28:31], s59 offen offset:0
    v_cvt_pk_bf16_f32 v8, v8, v9
    v_mfma_f32_16x16x32_bf16 v[52:55], v[156:159], a[24:27], v[52:55]
    v_cvt_pk_bf16_f32 v9, v10, v11
    ds_read_b64_tr_b16 v[106:107], v230 offset:36864
    v_mfma_f32_16x16x32_bf16 v[60:63], v[156:159], a[28:31], v[60:63]
    v_cvt_pk_bf16_f32 v10, v12, v13
    v_mfma_f32_16x16x32_bf16 v[56:59], v[152:155], a[28:31], v[56:59]
    v_cvt_pk_bf16_f32 v11, v14, v15
    ds_read_b64_tr_b16 v[108:109], v233 offset:32768
    v_mfma_f32_16x16x32_bf16 v[64:67], v[152:155], a[32:35], v[64:67]
    buffer_store_dwordx4 v[8:11], v238, s[28:31], s59 offen offset:1024
    v_cvt_pk_bf16_f32 v16, v16, v17
    v_mfma_f32_16x16x32_bf16 v[68:71], v[156:159], a[32:35], v[68:71]
    v_cvt_pk_bf16_f32 v17, v18, v19
    ds_read_b64_tr_b16 v[110:111], v233 offset:36864
    v_mfma_f32_16x16x32_bf16 v[76:79], v[156:159], a[36:39], v[76:79]
    v_cvt_pk_bf16_f32 v18, v20, v21
    v_mfma_f32_16x16x32_bf16 v[72:75], v[152:155], a[36:39], v[72:75]
    v_cvt_pk_bf16_f32 v19, v22, v23
    ds_read_b64_tr_b16 v[112:113], v230 offset:40960
    v_mfma_f32_16x16x32_bf16 v[80:83], v[152:155], a[40:43], v[80:83]
    buffer_store_dwordx4 v[16:19], v238, s[28:31], s59 offen offset:2048
    v_cvt_pk_bf16_f32 v24, v24, v25
    v_mfma_f32_16x16x32_bf16 v[84:87], v[156:159], a[40:43], v[84:87]
    v_cvt_pk_bf16_f32 v25, v26, v27
    v_mfma_f32_16x16x32_bf16 v[92:95], v[156:159], a[44:47], v[92:95]
    v_cvt_pk_bf16_f32 v26, v28, v29
    ds_read_b64_tr_b16 v[114:115], v230 offset:45056
    v_mfma_f32_16x16x32_bf16 v[88:91], v[152:155], a[44:47], v[88:91]
    v_cvt_pk_bf16_f32 v27, v30, v31
    v_mfma_f32_16x16x32_bf16 v[48:51], v[160:163], a[48:51], v[48:51]
    buffer_store_dwordx4 v[24:27], v239, s[28:31], s59 offen offset:0
    v_cvt_pk_bf16_f32 v32, v32, v33
    v_mfma_f32_16x16x32_bf16 v[52:55], v[164:167], a[48:51], v[52:55]
    v_cvt_pk_bf16_f32 v33, v34, v35
    ds_read_b64_tr_b16 v[116:117], v233 offset:40960
    v_mfma_f32_16x16x32_bf16 v[60:63], v[164:167], a[52:55], v[60:63]
    v_cvt_pk_bf16_f32 v34, v36, v37
    v_mfma_f32_16x16x32_bf16 v[56:59], v[160:163], a[52:55], v[56:59]
    v_cvt_pk_bf16_f32 v35, v38, v39
    ds_read_b64_tr_b16 v[118:119], v233 offset:45056
    v_mfma_f32_16x16x32_bf16 v[64:67], v[160:163], a[56:59], v[64:67]
    buffer_store_dwordx4 v[32:35], v239, s[28:31], s59 offen offset:1024
    v_cvt_pk_bf16_f32 v40, v40, v41
    v_mfma_f32_16x16x32_bf16 v[68:71], v[164:167], a[56:59], v[68:71]
    v_cvt_pk_bf16_f32 v41, v42, v43
    v_mfma_f32_16x16x32_bf16 v[76:79], v[164:167], a[60:63], v[76:79]
    v_cvt_pk_bf16_f32 v42, v44, v45
    v_mfma_f32_16x16x32_bf16 v[72:75], v[160:163], a[60:63], v[72:75]
    v_cvt_pk_bf16_f32 v43, v46, v47
    v_mfma_f32_16x16x32_bf16 v[80:83], v[160:163], a[64:67], v[80:83]
    buffer_store_dwordx4 v[40:43], v239, s[28:31], s59 offen offset:2048
    v_mfma_f32_16x16x32_bf16 v[84:87], v[164:167], a[64:67], v[84:87]
    v_mfma_f32_16x16x32_bf16 v[92:95], v[164:167], a[68:71], v[92:95]
    v_mfma_f32_16x16x32_bf16 v[88:91], v[160:163], a[68:71], v[88:91]
    s_waitcnt vmcnt(15) lgkmcnt(0)
    s_barrier
    v_mfma_f32_16x16x32_bf16 v[48:51], v[96:99], a[72:75], v[48:51]
    buffer_load_dword v244, off, s[8:11], s64 sc1
    v_mfma_f32_16x16x32_bf16 v[52:55], v[100:103], a[72:75], v[52:55]
    ds_read_b64_tr_b16 v[144:145], v231 offset:0
    v_mfma_f32_16x16x32_bf16 v[60:63], v[100:103], a[76:79], v[60:63]
    ds_read_b64_tr_b16 v[146:147], v231 offset:4096
    v_mfma_f32_16x16x32_bf16 v[56:59], v[96:99], a[76:79], v[56:59]
    s_add_u32 m0, s74, 27648
    v_mfma_f32_16x16x32_bf16 v[64:67], v[96:99], a[80:83], v[64:67]
    buffer_load_dwordx4 v218, s[44:47], s72 offen offset:0  lds
    v_mfma_f32_16x16x32_bf16 v[68:71], v[100:103], a[80:83], v[68:71]
    ds_read_b64_tr_b16 v[148:149], v234 offset:0
    v_mfma_f32_16x16x32_bf16 v[76:79], v[100:103], a[84:87], v[76:79]
    v_mfma_f32_16x16x32_bf16 v[72:75], v[96:99], a[84:87], v[72:75]
    ds_read_b64_tr_b16 v[150:151], v234 offset:4096
    v_mfma_f32_16x16x32_bf16 v[80:83], v[96:99], a[88:91], v[80:83]
    buffer_load_dwordx4 v219, s[44:47], s72 offen offset:1024  lds
    v_mfma_f32_16x16x32_bf16 v[84:87], v[100:103], a[88:91], v[84:87]
    v_mfma_f32_16x16x32_bf16 v[92:95], v[100:103], a[92:95], v[92:95]
    ds_read_b64_tr_b16 v[152:153], v231 offset:8192
    v_mfma_f32_16x16x32_bf16 v[88:91], v[96:99], a[92:95], v[88:91]
    v_mfma_f32_16x16x32_bf16 v[48:51], v[104:107], a[96:99], v[48:51]
    buffer_load_dwordx4 v220, s[44:47], s72 offen offset:2048  lds
    v_mfma_f32_16x16x32_bf16 v[52:55], v[108:111], a[96:99], v[52:55]
    ds_read_b64_tr_b16 v[154:155], v231 offset:12288
    v_mfma_f32_16x16x32_bf16 v[60:63], v[108:111], a[100:103], v[60:63]
    v_mfma_f32_16x16x32_bf16 v[56:59], v[104:107], a[100:103], v[56:59]
    s_add_u32 m0, s74, 49152
    s_add_u32 s72, s82, s84
    ds_read_b64_tr_b16 v[156:157], v234 offset:8192
    v_mfma_f32_16x16x32_bf16 v[64:67], v[104:107], a[104:107], v[64:67]
    buffer_load_dwordx4 v215, s[44:47], s72 offen offset:0  lds
    v_mfma_f32_16x16x32_bf16 v[68:71], v[108:111], a[104:107], v[68:71]
    ds_read_b64_tr_b16 v[158:159], v234 offset:12288
    v_mfma_f32_16x16x32_bf16 v[76:79], v[108:111], a[108:111], v[76:79]
    v_mfma_f32_16x16x32_bf16 v[72:75], v[104:107], a[108:111], v[72:75]
    ds_read_b64_tr_b16 v[160:161], v231 offset:16384
    v_mfma_f32_16x16x32_bf16 v[80:83], v[104:107], a[112:115], v[80:83]
    buffer_load_dwordx4 v216, s[44:47], s72 offen offset:1024  lds
    v_mfma_f32_16x16x32_bf16 v[84:87], v[108:111], a[112:115], v[84:87]
    v_mfma_f32_16x16x32_bf16 v[92:95], v[108:111], a[116:119], v[92:95]
    ds_read_b64_tr_b16 v[162:163], v231 offset:20480
    v_mfma_f32_16x16x32_bf16 v[88:91], v[104:107], a[116:119], v[88:91]
    v_mfma_f32_16x16x32_bf16 v[48:51], v[112:115], a[120:123], v[48:51]
    buffer_load_dwordx4 v217, s[44:47], s72 offen offset:2048  lds
    v_mfma_f32_16x16x32_bf16 v[52:55], v[116:119], a[120:123], v[52:55]
    ds_read_b64_tr_b16 v[164:165], v234 offset:16384
    v_mfma_f32_16x16x32_bf16 v[60:63], v[116:119], a[124:127], v[60:63]
    v_mfma_f32_16x16x32_bf16 v[56:59], v[112:115], a[124:127], v[56:59]
    s_add_u32 m0, s74, 52224
    ds_read_b64_tr_b16 v[166:167], v234 offset:20480
    v_mfma_f32_16x16x32_bf16 v[64:67], v[112:115], a[128:131], v[64:67]
    buffer_load_dwordx4 v218, s[44:47], s72 offen offset:0  lds
    v_mfma_f32_16x16x32_bf16 v[68:71], v[116:119], a[128:131], v[68:71]
    v_mfma_f32_16x16x32_bf16 v[76:79], v[116:119], a[132:135], v[76:79]
    v_mfma_f32_16x16x32_bf16 v[72:75], v[112:115], a[132:135], v[72:75]
    v_mfma_f32_16x16x32_bf16 v[80:83], v[112:115], a[136:139], v[80:83]
    buffer_load_dwordx4 v219, s[44:47], s72 offen offset:1024  lds
    v_mfma_f32_16x16x32_bf16 v[84:87], v[116:119], a[136:139], v[84:87]
    v_mfma_f32_16x16x32_bf16 v[92:95], v[116:119], a[140:143], v[92:95]
    v_mfma_f32_16x16x32_bf16 v[88:91], v[112:115], a[140:143], v[88:91]
    s_cmp_eq_u32 s1, 0
    s_waitcnt lgkmcnt(0)
    s_cbranch_scc1 L_f3
    s_waitcnt vmcnt(8) lgkmcnt(0)
    s_barrier
L_h3:
L_c2:
    v_readfirstlane_b32 s71, v244
    s_nop 0
    s_and_b32 s71, s71, 0xff
    s_cmp_ge_u32 s71, 2
    s_cbranch_scc0 L_s2
L_k2:
    v_mfma_f32_16x16x32_bf16 v[48:51], v[144:147], a[144:147], v[48:51]
    buffer_load_dwordx4 v[120:123], v238, s[28:31], s60 offen offset:0 sc1
    v_mfma_f32_16x16x32_bf16 v[52:55], v[148:151], a[144:147], v[52:55]
    ds_read_b64_tr_b16 v[96:97], v231 offset:24576
    v_mfma_f32_16x16x32_bf16 v[60:63], v[148:151], a[148:151], v[60:63]
    ds_read_b64_tr_b16 v[98:99], v231 offset:28672
    v_mfma_f32_16x16x32_bf16 v[56:59], v[144:147], a[148:151], v[56:59]
    v_mfma_f32_16x16x32_bf16 v[64:67], v[144:147], a[152:155], v[64:67]
    buffer_load_dwordx4 v[124:127], v238, s[28:31], s60 offen offset:1024 sc1
    v_mfma_f32_16x16x32_bf16 v[68:71], v[148:151], a[152:155], v[68:71]
    ds_read_b64_tr_b16 v[100:101], v234 offset:24576
    v_mfma_f32_16x16x32_bf16 v[76:79], v[148:151], a[156:159], v[76:79]
    v_mfma_f32_16x16x32_bf16 v[72:75], v[144:147], a[156:159], v[72:75]
    ds_read_b64_tr_b16 v[102:103], v234 offset:28672
    v_mfma_f32_16x16x32_bf16 v[80:83], v[144:147], a[160:163], v[80:83]
    buffer_load_dwordx4 v[128:131], v238, s[28:31], s60 offen offset:2048 sc1
    v_mfma_f32_16x16x32_bf16 v[84:87], v[148:151], a[160:163], v[84:87]
    v_mfma_f32_16x16x32_bf16 v[92:95], v[148:151], a[164:167], v[92:95]
    ds_read_b64_tr_b16 v[104:105], v231 offset:32768
    v_mfma_f32_16x16x32_bf16 v[88:91], v[144:147], a[164:167], v[88:91]
    v_mfma_f32_16x16x32_bf16 v[48:51], v[152:155], a[168:171], v[48:51]
    buffer_load_dwordx4 v[132:135], v239, s[28:31], s60 offen offset:0 sc1
    v_mfma_f32_16x16x32_bf16 v[52:55], v[156:159], a[168:171], v[52:55]
    ds_read_b64_tr_b16 v[106:107], v231 offset:36864
    v_mfma_f32_16x16x32_bf16 v[60:63], v[156:159], a[172:175], v[60:63]
    v_mfma_f32_16x16x32_bf16 v[56:59], v[152:155], a[172:175], v[56:59]
    ds_read_b64_tr_b16 v[108:109], v234 offset:32768
    v_mfma_f32_16x16x32_bf16 v[64:67], v[152:155], a[176:179], v[64:67]
    buffer_load_dwordx4 v[136:139], v239, s[28:31], s60 offen offset:1024 sc1
    v_mfma_f32_16x16x32_bf16 v[68:71], v[156:159], a[176:179], v[68:71]
    ds_read_b64_tr_b16 v[110:111], v234 offset:36864
    v_mfma_f32_16x16x32_bf16 v[76:79], v[156:159], a[180:183], v[76:79]
    v_mfma_f32_16x16x32_bf16 v[72:75], v[152:155], a[180:183], v[72:75]
    ds_read_b64_tr_b16 v[112:113], v231 offset:40960
    v_mfma_f32_16x16x32_bf16 v[80:83], v[152:155], a[184:187], v[80:83]
    buffer_load_dwordx4 v[140:143], v239, s[28:31], s60 offen offset:2048 sc1
    v_mfma_f32_16x16x32_bf16 v[84:87], v[156:159], a[184:187], v[84:87]
    v_mfma_f32_16x16x32_bf16 v[92:95], v[156:159], a[188:191], v[92:95]
    ds_read_b64_tr_b16 v[114:115], v231 offset:45056
    v_mfma_f32_16x16x32_bf16 v[88:91], v[152:155], a[188:191], v[88:91]
    s_add_u32 s71, s0, 3
    v_mov_b32 v242, s71
    v_mfma_f32_16x16x32_bf16 v[48:51], v[160:163], a[192:195], v[48:51]
    buffer_store_dword v242, v243, s[4:7], 0 offen
    v_mfma_f32_16x16x32_bf16 v[52:55], v[164:167], a[192:195], v[52:55]
    ds_read_b64_tr_b16 v[116:117], v234 offset:40960
    v_mfma_f32_16x16x32_bf16 v[60:63], v[164:167], a[196:199], v[60:63]
    v_mfma_f32_16x16x32_bf16 v[56:59], v[160:163], a[196:199], v[56:59]
    ds_read_b64_tr_b16 v[118:119], v234 offset:45056
    v_mfma_f32_16x16x32_bf16 v[64:67], v[160:163], a[200:203], v[64:67]
    buffer_load_dwordx4 v220, s[44:47], s72 offen offset:2048  lds
    v_mfma_f32_16x16x32_bf16 v[68:71], v[164:167], a[200:203], v[68:71]
    v_mfma_f32_16x16x32_bf16 v[76:79], v[164:167], a[204:207], v[76:79]
    v_mfma_f32_16x16x32_bf16 v[72:75], v[160:163], a[204:207], v[72:75]
    s_mov_b32 m0, s74
    s_add_u32 s72, s82, s85
    v_mfma_f32_16x16x32_bf16 v[80:83], v[160:163], a[208:211], v[80:83]
    buffer_load_dwordx4 v215, s[44:47], s72 offen offset:0  lds
    v_mfma_f32_16x16x32_bf16 v[84:87], v[164:167], a[208:211], v[84:87]
    v_mfma_f32_16x16x32_bf16 v[92:95], v[164:167], a[212:215], v[92:95]
    v_mfma_f32_16x16x32_bf16 v[88:91], v[160:163], a[212:215], v[88:91]
    s_waitcnt vmcnt(14) lgkmcnt(0)
    s_barrier
    v_mfma_f32_16x16x32_bf16 v[48:51], v[96:99], a[216:219], v[48:51]
    buffer_load_dwordx4 v216, s[44:47], s72 offen offset:1024  lds
    v_mfma_f32_16x16x32_bf16 v[52:55], v[100:103], a[216:219], v[52:55]
    ds_read_b64_tr_b16 v[144:145], v229 offset:24576
    v_mfma_f32_16x16x32_bf16 v[60:63], v[100:103], a[220:223], v[60:63]
    ds_read_b64_tr_b16 v[146:147], v229 offset:28672
    v_mfma_f32_16x16x32_bf16 v[56:59], v[96:99], a[220:223], v[56:59]
    v_mfma_f32_16x16x32_bf16 v[64:67], v[96:99], a[224:227], v[64:67]
    buffer_load_dwordx4 v217, s[44:47], s72 offen offset:2048  lds
    v_mfma_f32_16x16x32_bf16 v[68:71], v[100:103], a[224:227], v[68:71]
    ds_read_b64_tr_b16 v[148:149], v232 offset:24576
    v_mfma_f32_16x16x32_bf16 v[76:79], v[100:103], a[228:231], v[76:79]
    v_mfma_f32_16x16x32_bf16 v[72:75], v[96:99], a[228:231], v[72:75]
    s_add_u32 m0, s74, 3072
    ds_read_b64_tr_b16 v[150:151], v232 offset:28672
    v_mfma_f32_16x16x32_bf16 v[80:83], v[96:99], a[232:235], v[80:83]
    buffer_load_dwordx4 v218, s[44:47], s72 offen offset:0  lds
    v_mfma_f32_16x16x32_bf16 v[84:87], v[100:103], a[232:235], v[84:87]
    v_mfma_f32_16x16x32_bf16 v[92:95], v[100:103], a[236:239], v[92:95]
    ds_read_b64_tr_b16 v[152:153], v229 offset:32768
    v_mfma_f32_16x16x32_bf16 v[88:91], v[96:99], a[236:239], v[88:91]
    v_mfma_f32_16x16x32_bf16 v[48:51], v[104:107], a[240:243], v[48:51]
    buffer_load_dwordx4 v219, s[44:47], s72 offen offset:1024  lds
    v_mfma_f32_16x16x32_bf16 v[52:55], v[108:111], a[240:243], v[52:55]
    s_waitcnt vmcnt(12)
    v_mfma_f32_16x16x32_bf16 v[0:3], v[202:205], v[120:123], 0
    v_mfma_f32_16x16x32_bf16 v[4:7], v[200:203], v[120:123], 0
    ds_read_b64_tr_b16 v[154:155], v229 offset:36864
    v_mfma_f32_16x16x32_bf16 v[60:63], v[108:111], a[244:247], v[60:63]
    v_mfma_f32_16x16x32_bf16 v[56:59], v[104:107], a[244:247], v[56:59]
    ds_read_b64_tr_b16 v[156:157], v232 offset:32768
    v_mfma_f32_16x16x32_bf16 v[64:67], v[104:107], a[248:251], v[64:67]
    buffer_load_dwordx4 v220, s[44:47], s72 offen offset:2048  lds
    v_mfma_f32_16x16x32_bf16 v[68:71], v[108:111], a[248:251], v[68:71]
    s_waitcnt vmcnt(12)
    v_mfma_f32_16x16x32_bf16 v[8:11], v[202:205], v[124:127], 0
    v_mfma_f32_16x16x32_bf16 v[12:15], v[200:203], v[124:127], 0
    ds_read_b64_tr_b16 v[158:159], v232 offset:36864
    v_mfma_f32_16x16x32_bf16 v[76:79], v[108:111], a[252:255], v[76:79]
    v_mfma_f32_16x16x32_bf16 v[72:75], v[104:107], a[252:255], v[72:75]
    s_add_u32 m0, s74, 73728
    s_add_u32 s72, s82, s86
    ds_read_b64_tr_b16 v[160:161], v229 offset:40960
    v_mfma_f32_16x16x32_bf16 v[80:83], v[104:107], v[168:171], v[80:83]
    buffer_load_dwordx4 v215, s[44:47], s72 offen offset:0  lds
    v_mfma_f32_16x16x32_bf16 v[84:87], v[108:111], v[168:171], v[84:87]
    s_waitcnt vmcnt(12)
    v_mfma_f32_16x16x32_bf16 v[16:19], v[202:205], v[128:131], 0
    v_mfma_f32_16x16x32_bf16 v[20:23], v[200:203], v[128:131], 0
    v_mfma_f32_16x16x32_bf16 v[92:95], v[108:111], v[172:175], v[92:95]
    ds_read_b64_tr_b16 v[162:163], v229 offset:45056
    v_mfma_f32_16x16x32_bf16 v[88:91], v[104:107], v[172:175], v[88:91]
    v_mfma_f32_16x16x32_bf16 v[48:51], v[112:115], v[176:179], v[48:51]
    buffer_load_dwordx4 v216, s[44:47], s72 offen offset:1024  lds
    v_mfma_f32_16x16x32_bf16 v[52:55], v[116:119], v[176:179], v[52:55]
    s_waitcnt vmcnt(12)
    v_mfma_f32_16x16x32_bf16 v[24:27], v[202:205], v[132:135], 0
    v_mfma_f32_16x16x32_bf16 v[28:31], v[200:203], v[132:135], 0
    ds_read_b64_tr_b16 v[164:165], v232 offset:40960
    v_mfma_f32_16x16x32_bf16 v[60:63], v[116:119], v[180:183], v[60:63]
    v_mfma_f32_16x16x32_bf16 v[56:59], v[112:115], v[180:183], v[56:59]
    ds_read_b64_tr_b16 v[166:167], v232 offset:45056
    v_mfma_f32_16x16x32_bf16 v[64:67], v[112:115], v[184:187], v[64:67]
    buffer_load_dwordx4 v217, s[44:47], s72 offen offset:2048  lds
    v_mfma_f32_16x16x32_bf16 v[68:71], v[116:119], v[184:187], v[68:71]
    s_waitcnt vmcnt(12)
    v_mfma_f32_16x16x32_bf16 v[32:35], v[202:205], v[136:139], 0
    v_mfma_f32_16x16x32_bf16 v[36:39], v[200:203], v[136:139], 0
    v_mfma_f32_16x16x32_bf16 v[76:79], v[116:119], v[188:191], v[76:79]
    v_mfma_f32_16x16x32_bf16 v[72:75], v[112:115], v[188:191], v[72:75]
    s_add_u32 m0, s74, 76800
    v_mfma_f32_16x16x32_bf16 v[80:83], v[112:115], v[192:195], v[80:83]
    buffer_load_dwordx4 v218, s[44:47], s72 offen offset:0  lds
    v_mfma_f32_16x16x32_bf16 v[84:87], v[116:119], v[192:195], v[84:87]
    s_waitcnt vmcnt(12)
    v_mfma_f32_16x16x32_bf16 v[40:43], v[202:205], v[140:143], 0
    v_mfma_f32_16x16x32_bf16 v[44:47], v[200:203], v[140:143], 0
    v_mfma_f32_16x16x32_bf16 v[92:95], v[116:119], v[196:199], v[92:95]
    v_mfma_f32_16x16x32_bf16 v[88:91], v[112:115], v[196:199], v[88:91]
    s_waitcnt vmcnt(10) lgkmcnt(0)
    s_barrier
    v_mfma_f32_16x16x32_bf16 v[0:3], v[144:147], a[0:3], v[0:3]
    buffer_load_dwordx4 v219, s[44:47], s72 offen offset:1024  lds
    v_mfma_f32_16x16x32_bf16 v[4:7], v[148:151], a[0:3], v[4:7]
    ds_read_b64_tr_b16 v[96:97], v230 offset:0
    v_mfma_f32_16x16x32_bf16 v[12:15], v[148:151], a[4:7], v[12:15]
    ds_read_b64_tr_b16 v[98:99], v230 offset:4096
    v_mfma_f32_16x16x32_bf16 v[8:11], v[144:147], a[4:7], v[8:11]
    v_mfma_f32_16x16x32_bf16 v[16:19], v[144:147], a[8:11], v[16:19]
    buffer_load_dwordx4 v220, s[44:47], s72 offen offset:2048  lds
    v_cvt_pk_bf16_f32 v48, v48, v49
    v_mfma_f32_16x16x32_bf16 v[20:23], v[148:151], a[8:11], v[20:23]
    v_cvt_pk_bf16_f32 v49, v50, v51
    ds_read_b64_tr_b16 v[100:101], v233 offset:0
    v_mfma_f32_16x16x32_bf16 v[28:31], v[148:151], a[12:15], v[28:31]
    v_cvt_pk_bf16_f32 v50, v52, v53
    v_mfma_f32_16x16x32_bf16 v[24:27], v[144:147], a[12:15], v[24:27]
    v_cvt_pk_bf16_f32 v51, v54, v55
    ds_read_b64_tr_b16 v[102:103], v233 offset:4096
    v_mfma_f32_16x16x32_bf16 v[32:35], v[144:147], a[16:19], v[32:35]
    buffer_store_dwordx4 v[48:51], v238, s[28:31], s60 offen offset:0 sc1
    v_cvt_pk_bf16_f32 v56, v56, v57
    v_mfma_f32_16x16x32_bf16 v[36:39], v[148:151], a[16:19], v[36:39]
    v_cvt_pk_bf16_f32 v57, v58, v59
    v_mfma_f32_16x16x32_bf16 v[44:47], v[148:151], a[20:23], v[44:47]
    v_cvt_pk_bf16_f32 v58, v60, v61
    ds_read_b64_tr_b16 v[104:105], v230 offset:8192
    v_mfma_f32_16x16x32_bf16 v[40:43], v[144:147], a[20:23], v[40:43]
    v_cvt_pk_bf16_f32 v59, v62, v63
    v_mfma_f32_16x16x32_bf16 v[0:3], v[152:155], a[24:27], v[0:3]
    buffer_store_dwordx4 v[56:59], v238, s[28:31], s60 offen offset:1024 sc1
    v_cvt_pk_bf16_f32 v64, v64, v65
    v_mfma_f32_16x16x32_bf16 v[4:7], v[156:159], a[24:27], v[4:7]
    v_cvt_pk_bf16_f32 v65, v66, v67
    ds_read_b64_tr_b16 v[106:107], v230 offset:12288
    v_mfma_f32_16x16x32_bf16 v[12:15], v[156:159], a[28:31], v[12:15]
    v_cvt_pk_bf16_f32 v66, v68, v69
    v_mfma_f32_16x16x32_bf16 v[8:11], v[152:155], a[28:31], v[8:11]
    v_cvt_pk_bf16_f32 v67, v70, v71
    ds_read_b64_tr_b16 v[108:109], v233 offset:8192
    v_mfma_f32_16x16x32_bf16 v[16:19], v[152:155], a[32:35], v[16:19]
    buffer_store_dwordx4 v[64:67], v238, s[28:31], s60 offen offset:2048 sc1
    v_cvt_pk_bf16_f32 v72, v72, v73
    v_mfma_f32_16x16x32_bf16 v[20:23], v[156:159], a[32:35], v[20:23]
    v_cvt_pk_bf16_f32 v73, v74, v75
    ds_read_b64_tr_b16 v[110:111], v233 offset:12288
    v_mfma_f32_16x16x32_bf16 v[28:31], v[156:159], a[36:39], v[28:31]
    v_cvt_pk_bf16_f32 v74, v76, v77
    v_mfma_f32_16x16x32_bf16 v[24:27], v[152:155], a[36:39], v[24:27]
    v_cvt_pk_bf16_f32 v75, v78, v79
    ds_read_b64_tr_b16 v[112:113], v230 offset:16384
    v_mfma_f32_16x16x32_bf16 v[32:35], v[152:155], a[40:43], v[32:35]
    buffer_store_dwordx4 v[72:75], v239, s[28:31], s60 offen offset:0 sc1
    v_cvt_pk_bf16_f32 v80, v80, v81
    v_mfma_f32_16x16x32_bf16 v[36:39], v[156:159], a[40:43], v[36:39]
    v_cvt_pk_bf16_f32 v81, v82, v83
    v_mfma_f32_16x16x32_bf16 v[44:47], v[156:159], a[44:47], v[44:47]
    v_cvt_pk_bf16_f32 v82, v84, v85
    ds_read_b64_tr_b16 v[114:115], v230 offset:20480
    v_mfma_f32_16x16x32_bf16 v[40:43], v[152:155], a[44:47], v[40:43]
    v_cvt_pk_bf16_f32 v83, v86, v87
    v_mfma_f32_16x16x32_bf16 v[0:3], v[160:163], a[48:51], v[0:3]
    buffer_store_dwordx4 v[80:83], v239, s[28:31], s60 offen offset:1024 sc1
    v_cvt_pk_bf16_f32 v88, v88, v89
    v_mfma_f32_16x16x32_bf16 v[4:7], v[164:167], a[48:51], v[4:7]
    v_cvt_pk_bf16_f32 v89, v90, v91
    ds_read_b64_tr_b16 v[116:117], v233 offset:16384
    v_mfma_f32_16x16x32_bf16 v[12:15], v[164:167], a[52:55], v[12:15]
    v_cvt_pk_bf16_f32 v90, v92, v93
    v_mfma_f32_16x16x32_bf16 v[8:11], v[160:163], a[52:55], v[8:11]
    v_cvt_pk_bf16_f32 v91, v94, v95
    ds_read_b64_tr_b16 v[118:119], v233 offset:20480
    v_mfma_f32_16x16x32_bf16 v[16:19], v[160:163], a[56:59], v[16:19]
    buffer_store_dwordx4 v[88:91], v239, s[28:31], s60 offen offset:2048 sc1
    v_mfma_f32_16x16x32_bf16 v[20:23], v[164:167], a[56:59], v[20:23]
    v_mfma_f32_16x16x32_bf16 v[28:31], v[164:167], a[60:63], v[28:31]
    v_mfma_f32_16x16x32_bf16 v[24:27], v[160:163], a[60:63], v[24:27]
    v_mfma_f32_16x16x32_bf16 v[32:35], v[160:163], a[64:67], v[32:35]
    v_mfma_f32_16x16x32_bf16 v[36:39], v[164:167], a[64:67], v[36:39]
    v_mfma_f32_16x16x32_bf16 v[44:47], v[164:167], a[68:71], v[44:47]
    v_mfma_f32_16x16x32_bf16 v[40:43], v[160:163], a[68:71], v[40:43]
    s_waitcnt vmcnt(12) lgkmcnt(0)
    s_barrier
    v_mfma_f32_16x16x32_bf16 v[0:3], v[96:99], a[72:75], v[0:3]
    ds_read_b64_tr_b16 v[144:145], v229 offset:0
    v_mfma_f32_16x16x32_bf16 v[4:7], v[100:103], a[72:75], v[4:7]
    buffer_load_dword v244, off, s[8:11], s65 sc1
    v_mfma_f32_16x16x32_bf16 v[12:15], v[100:103], a[76:79], v[12:15]
    v_mfma_f32_16x16x32_bf16 v[8:11], v[96:99], a[76:79], v[8:11]
    ds_read_b64_tr_b16 v[146:147], v229 offset:4096
    v_mfma_f32_16x16x32_bf16 v[16:19], v[96:99], a[80:83], v[16:19]
    v_mfma_f32_16x16x32_bf16 v[20:23], v[100:103], a[80:83], v[20:23]
    ds_read_b64_tr_b16 v[148:149], v232 offset:0
    v_mfma_f32_16x16x32_bf16 v[28:31], v[100:103], a[84:87], v[28:31]
    v_mfma_f32_16x16x32_bf16 v[24:27], v[96:99], a[84:87], v[24:27]
    v_mfma_f32_16x16x32_bf16 v[32:35], v[96:99], a[88:91], v[32:35]
    ds_read_b64_tr_b16 v[150:151], v232 offset:4096
    v_mfma_f32_16x16x32_bf16 v[36:39], v[100:103], a[88:91], v[36:39]
    v_mfma_f32_16x16x32_bf16 v[44:47], v[100:103], a[92:95], v[44:47]
    ds_read_b64_tr_b16 v[152:153], v229 offset:8192
    v_mfma_f32_16x16x32_bf16 v[40:43], v[96:99], a[92:95], v[40:43]
    v_mfma_f32_16x16x32_bf16 v[0:3], v[104:107], a[96:99], v[0:3]
    v_mfma_f32_16x16x32_bf16 v[4:7], v[108:111], a[96:99], v[4:7]
    ds_read_b64_tr_b16 v[154:155], v229 offset:12288
    v_mfma_f32_16x16x32_bf16 v[12:15], v[108:111], a[100:103], v[12:15]
    v_mfma_f32_16x16x32_bf16 v[8:11], v[104:107], a[100:103], v[8:11]
    ds_read_b64_tr_b16 v[156:157], v232 offset:8192
    v_mfma_f32_16x16x32_bf16 v[16:19], v[104:107], a[104:107], v[16:19]
    v_mfma_f32_16x16x32_bf16 v[20:23], v[108:111], a[104:107], v[20:23]
    ds_read_b64_tr_b16 v[158:159], v232 offset:12288
    v_mfma_f32_16x16x32_bf16 v[28:31], v[108:111], a[108:111], v[28:31]
    v_mfma_f32_16x16x32_bf16 v[24:27], v[104:107], a[108:111], v[24:27]
    v_mfma_f32_16x16x32_bf16 v[32:35], v[104:107], a[112:115], v[32:35]
    ds_read_b64_tr_b16 v[160:161], v229 offset:16384
    v_mfma_f32_16x16x32_bf16 v[36:39], v[108:111], a[112:115], v[36:39]
    v_mfma_f32_16x16x32_bf16 v[44:47], v[108:111], a[116:119], v[44:47]
    ds_read_b64_tr_b16 v[162:163], v229 offset:20480
    v_mfma_f32_16x16x32_bf16 v[40:43], v[104:107], a[116:119], v[40:43]
    v_mfma_f32_16x16x32_bf16 v[0:3], v[112:115], a[120:123], v[0:3]
    v_mfma_f32_16x16x32_bf16 v[4:7], v[116:119], a[120:123], v[4:7]
    ds_read_b64_tr_b16 v[164:165], v232 offset:16384
    v_mfma_f32_16x16x32_bf16 v[12:15], v[116:119], a[124:127], v[12:15]
    v_mfma_f32_16x16x32_bf16 v[8:11], v[112:115], a[124:127], v[8:11]
    ds_read_b64_tr_b16 v[166:167], v232 offset:20480
    v_mfma_f32_16x16x32_bf16 v[16:19], v[112:115], a[128:131], v[16:19]
    v_mfma_f32_16x16x32_bf16 v[20:23], v[116:119], a[128:131], v[20:23]
    v_mfma_f32_16x16x32_bf16 v[28:31], v[116:119], a[132:135], v[28:31]
    v_mfma_f32_16x16x32_bf16 v[24:27], v[112:115], a[132:135], v[24:27]
    v_mfma_f32_16x16x32_bf16 v[32:35], v[112:115], a[136:139], v[32:35]
    v_mfma_f32_16x16x32_bf16 v[36:39], v[116:119], a[136:139], v[36:39]
    v_mfma_f32_16x16x32_bf16 v[44:47], v[116:119], a[140:143], v[44:47]
    v_mfma_f32_16x16x32_bf16 v[40:43], v[112:115], a[140:143], v[40:43]
    s_waitcnt vmcnt(0) lgkmcnt(0)
    s_barrier
L_c3:
    v_readfirstlane_b32 s71, v244
    s_nop 0
    s_and_b32 s71, s71, 0xff
    s_cmp_ge_u32 s71, 3
    s_cbranch_scc0 L_s3
L_k3:
    v_mfma_f32_16x16x32_bf16 v[0:3], v[144:147], a[144:147], v[0:3]
    ds_read_b64_tr_b16 v[96:97], v230 offset:24576
    v_mfma_f32_16x16x32_bf16 v[4:7], v[148:151], a[144:147], v[4:7]
    buffer_load_dwordx4 v[120:123], v238, s[28:31], s61 offen offset:0 sc1
    v_mfma_f32_16x16x32_bf16 v[12:15], v[148:151], a[148:151], v[12:15]
    v_mfma_f32_16x16x32_bf16 v[8:11], v[144:147], a[148:151], v[8:11]
    ds_read_b64_tr_b16 v[98:99], v230 offset:28672
    v_mfma_f32_16x16x32_bf16 v[16:19], v[144:147], a[152:155], v[16:19]
    v_mfma_f32_16x16x32_bf16 v[20:23], v[148:151], a[152:155], v[20:23]
    ds_read_b64_tr_b16 v[100:101], v233 offset:24576
    v_mfma_f32_16x16x32_bf16 v[28:31], v[148:151], a[156:159], v[28:31]
    buffer_load_dwordx4 v[124:127], v238, s[28:31], s61 offen offset:1024 sc1
    v_mfma_f32_16x16x32_bf16 v[24:27], v[144:147], a[156:159], v[24:27]
    v_mfma_f32_16x16x32_bf16 v[32:35], v[144:147], a[160:163], v[32:35]
    ds_read_b64_tr_b16 v[102:103], v233 offset:28672
    v_mfma_f32_16x16x32_bf16 v[36:39], v[148:151], a[160:163], v[36:39]
    v_mfma_f32_16x16x32_bf16 v[44:47], v[148:151], a[164:167], v[44:47]
    ds_read_b64_tr_b16 v[104:105], v230 offset:32768
    v_mfma_f32_16x16x32_bf16 v[40:43], v[144:147], a[164:167], v[40:43]
    buffer_load_dwordx4 v[128:131], v238, s[28:31], s61 offen offset:2048 sc1
    v_mfma_f32_16x16x32_bf16 v[0:3], v[152:155], a[168:171], v[0:3]
    v_mfma_f32_16x16x32_bf16 v[4:7], v[156:159], a[168:171], v[4:7]
    ds_read_b64_tr_b16 v[106:107], v230 offset:36864
    v_mfma_f32_16x16x32_bf16 v[12:15], v[156:159], a[172:175], v[12:15]
    v_mfma_f32_16x16x32_bf16 v[8:11], v[152:155], a[172:175], v[8:11]
    ds_read_b64_tr_b16 v[108:109], v233 offset:32768
    v_mfma_f32_16x16x32_bf16 v[16:19], v[152:155], a[176:179], v[16:19]
    buffer_load_dwordx4 v[132:135], v239, s[28:31], s61 offen offset:0 sc1
    v_mfma_f32_16x16x32_bf16 v[20:23], v[156:159], a[176:179], v[20:23]
    v_mfma_f32_16x16x32_bf16 v[28:31], v[156:159], a[180:183], v[28:31]
    ds_read_b64_tr_b16 v[110:111], v233 offset:36864
    v_mfma_f32_16x16x32_bf16 v[24:27], v[152:155], a[180:183], v[24:27]
    v_mfma_f32_16x16x32_bf16 v[32:35], v[152:155], a[184:187], v[32:35]
    ds_read_b64_tr_b16 v[112:113], v230 offset:40960
    v_mfma_f32_16x16x32_bf16 v[36:39], v[156:159], a[184:187], v[36:39]
    buffer_load_dwordx4 v[136:139], v239, s[28:31], s61 offen offset:1024 sc1
    v_mfma_f32_16x16x32_bf16 v[44:47], v[156:159], a[188:191], v[44:47]
    v_mfma_f32_16x16x32_bf16 v[40:43], v[152:155], a[188:191], v[40:43]
    ds_read_b64_tr_b16 v[114:115], v230 offset:45056
    v_mfma_f32_16x16x32_bf16 v[0:3], v[160:163], a[192:195], v[0:3]
    v_mfma_f32_16x16x32_bf16 v[4:7], v[164:167], a[192:195], v[4:7]
    ds_read_b64_tr_b16 v[116:117], v233 offset:40960
    v_mfma_f32_16x16x32_bf16 v[12:15], v[164:167], a[196:199], v[12:15]
    buffer_load_dwordx4 v[140:143], v239, s[28:31], s61 offen offset:2048 sc1
    v_mfma_f32_16x16x32_bf16 v[8:11], v[160:163], a[196:199], v[8:11]
    v_mfma_f32_16x16x32_bf16 v[16:19], v[160:163], a[200:203], v[16:19]
    ds_read_b64_tr_b16 v[118:119], v233 offset:45056
    v_mfma_f32_16x16x32_bf16 v[20:23], v[164:167], a[200:203], v[20:23]
    v_mfma_f32_16x16x32_bf16 v[28:31], v[164:167], a[204:207], v[28:31]
    v_mfma_f32_16x16x32_bf16 v[24:27], v[160:163], a[204:207], v[24:27]
    v_mfma_f32_16x16x32_bf16 v[32:35], v[160:163], a[208:211], v[32:35]
    v_mfma_f32_16x16x32_bf16 v[36:39], v[164:167], a[208:211], v[36:39]
    v_mfma_f32_16x16x32_bf16 v[44:47], v[164:167], a[212:215], v[44:47]
    v_mfma_f32_16x16x32_bf16 v[40:43], v[160:163], a[212:215], v[40:43]
    s_waitcnt lgkmcnt(10)
    v_mfma_f32_16x16x32_bf16 v[0:3], v[96:99], a[216:219], v[0:3]
    s_waitcnt lgkmcnt(8)
    v_mfma_f32_16x16x32_bf16 v[4:7], v[100:103], a[216:219], v[4:7]
    s_waitcnt vmcnt(5)
    v_mfma_f32_16x16x32_bf16 v[0:3], v[202:205], v[120:123], v[0:3]
    v_mfma_f32_16x16x32_bf16 v[4:7], v[200:203], v[120:123], v[4:7]
    s_waitcnt lgkmcnt(6)
    v_mfma_f32_16x16x32_bf16 v[0:3], v[104:107], a[240:243], v[0:3]
    s_waitcnt lgkmcnt(4)
    v_mfma_f32_16x16x32_bf16 v[4:7], v[108:111], a[240:243], v[4:7]
    s_waitcnt lgkmcnt(2)
    v_mfma_f32_16x16x32_bf16 v[0:3], v[112:115], v[176:179], v[0:3]
    s_waitcnt lgkmcnt(0)
    v_mfma_f32_16x16x32_bf16 v[4:7], v[116:119], v[176:179], v[4:7]
    v_mfma_f32_16x16x32_bf16 v[8:11], v[96:99], a[220:223], v[8:11]
    v_mfma_f32_16x16x32_bf16 v[12:15], v[100:103], a[220:223], v[12:15]
    s_waitcnt vmcnt(4)
    v_mfma_f32_16x16x32_bf16 v[8:11], v[202:205], v[124:127], v[8:11]
    v_mfma_f32_16x16x32_bf16 v[12:15], v[200:203], v[124:127], v[12:15]
    v_mfma_f32_16x16x32_bf16 v[8:11], v[104:107], a[244:247], v[8:11]
    v_mfma_f32_16x16x32_bf16 v[12:15], v[108:111], a[244:247], v[12:15]
    v_mfma_f32_16x16x32_bf16 v[8:11], v[112:115], v[180:183], v[8:11]
    v_cvt_pk_bf16_f32 v0, v0, v1
    v_mfma_f32_16x16x32_bf16 v[12:15], v[116:119], v[180:183], v[12:15]
    v_cvt_pk_bf16_f32 v1, v2, v3
    v_mfma_f32_16x16x32_bf16 v[16:19], v[96:99], a[224:227], v[16:19]
    v_cvt_pk_bf16_f32 v2, v4, v5
    v_mfma_f32_16x16x32_bf16 v[20:23], v[100:103], a[224:227], v[20:23]
    s_waitcnt vmcnt(3)
    v_mfma_f32_16x16x32_bf16 v[16:19], v[202:205], v[128:131], v[16:19]
    v_mfma_f32_16x16x32_bf16 v[20:23], v[200:203], v[128:131], v[20:23]
    v_cvt_pk_bf16_f32 v3, v6, v7
    v_mfma_f32_16x16x32_bf16 v[16:19], v[104:107], a[248:251], v[16:19]
    buffer_store_dwordx4 v[0:3], v238, s[28:31], s61 offen offset:0 sc1
    v_mfma_f32_16x16x32_bf16 v[20:23], v[108:111], a[248:251], v[20:23]
    v_mfma_f32_16x16x32_bf16 v[16:19], v[112:115], v[184:187], v[16:19]
    v_cvt_pk_bf16_f32 v8, v8, v9
    v_mfma_f32_16x16x32_bf16 v[20:23], v[116:119], v[184:187], v[20:23]
    v_cvt_pk_bf16_f32 v9, v10, v11
    v_mfma_f32_16x16x32_bf16 v[24:27], v[96:99], a[228:231], v[24:27]
    v_cvt_pk_bf16_f32 v10, v12, v13
    v_mfma_f32_16x16x32_bf16 v[28:31], v[100:103], a[228:231], v[28:31]
    s_waitcnt vmcnt(3)
    v_mfma_f32_16x16x32_bf16 v[24:27], v[202:205], v[132:135], v[24:27]
    v_mfma_f32_16x16x32_bf16 v[28:31], v[200:203], v[132:135], v[28:31]
    v_cvt_pk_bf16_f32 v11, v14, v15
    v_mfma_f32_16x16x32_bf16 v[24:27], v[104:107], a[252:255], v[24:27]
    buffer_store_dwordx4 v[8:11], v238, s[28:31], s61 offen offset:1024 sc1
    v_mfma_f32_16x16x32_bf16 v[28:31], v[108:111], a[252:255], v[28:31]
    v_mfma_f32_16x16x32_bf16 v[24:27], v[112:115], v[188:191], v[24:27]
    v_cvt_pk_bf16_f32 v16, v16, v17
    v_mfma_f32_16x16x32_bf16 v[28:31], v[116:119], v[188:191], v[28:31]
    v_cvt_pk_bf16_f32 v17, v18, v19
    v_mfma_f32_16x16x32_bf16 v[32:35], v[96:99], a[232:235], v[32:35]
    v_cvt_pk_bf16_f32 v18, v20, v21
    v_mfma_f32_16x16x32_bf16 v[36:39], v[100:103], a[232:235], v[36:39]
    s_waitcnt vmcnt(3)
    v_mfma_f32_16x16x32_bf16 v[32:35], v[202:205], v[136:139], v[32:35]
    v_mfma_f32_16x16x32_bf16 v[36:39], v[200:203], v[136:139], v[36:39]
    v_cvt_pk_bf16_f32 v19, v22, v23
    v_mfma_f32_16x16x32_bf16 v[32:35], v[104:107], v[168:171], v[32:35]
    buffer_store_dwordx4 v[16:19], v238, s[28:31], s61 offen offset:2048 sc1
    v_mfma_f32_16x16x32_bf16 v[36:39], v[108:111], v[168:171], v[36:39]
    v_mfma_f32_16x16x32_bf16 v[32:35], v[112:115], v[192:195], v[32:35]
    v_cvt_pk_bf16_f32 v24, v24, v25
    v_mfma_f32_16x16x32_bf16 v[36:39], v[116:119], v[192:195], v[36:39]
    v_cvt_pk_bf16_f32 v25, v26, v27
    v_mfma_f32_16x16x32_bf16 v[40:43], v[96:99], a[236:239], v[40:43]
    v_cvt_pk_bf16_f32 v26, v28, v29
    v_mfma_f32_16x16x32_bf16 v[44:47], v[100:103], a[236:239], v[44:47]
    s_waitcnt vmcnt(3)
    v_mfma_f32_16x16x32_bf16 v[40:43], v[202:205], v[140:143], v[40:43]
    v_mfma_f32_16x16x32_bf16 v[44:47], v[200:203], v[140:143], v[44:47]
    v_cvt_pk_bf16_f32 v27, v30, v31
    v_mfma_f32_16x16x32_bf16 v[40:43], v[104:107], v[172:175], v[40:43]
    buffer_store_dwordx4 v[24:27], v239, s[28:31], s61 offen offset:0 sc1
    v_mfma_f32_16x16x32_bf16 v[44:47], v[108:111], v[172:175], v[44:47]
    v_mfma_f32_16x16x32_bf16 v[40:43], v[112:115], v[196:199], v[40:43]
    v_mfma_f32_16x16x32_bf16 v[44:47], v[116:119], v[196:199], v[44:47]
    v_cvt_pk_bf16_f32 v32, v32, v33
    v_cvt_pk_bf16_f32 v33, v34, v35
    v_cvt_pk_bf16_f32 v34, v36, v37
    v_cvt_pk_bf16_f32 v35, v38, v39
    buffer_store_dwordx4 v[32:35], v239, s[28:31], s61 offen offset:1024 sc1
    s_nop 1
    v_cvt_pk_bf16_f32 v40, v40, v41
    v_cvt_pk_bf16_f32 v41, v42, v43
    v_cvt_pk_bf16_f32 v42, v44, v45
    v_cvt_pk_bf16_f32 v43, v46, v47
    buffer_store_dwordx4 v[40:43], v239, s[28:31], s61 offen offset:2048 sc1
    s_add_u32 s70, s76, 3
    s_cmp_ge_u32 s70, 5
    s_cselect_b32 s73, 5, 0
    s_sub_u32 s70, s70, s73
    s_lshl_b32 s57, s70, 8
    s_add_u32 s70, s76, 2
    s_cmp_ge_u32 s70, 5
    s_cselect_b32 s73, 5, 0
    s_sub_u32 s70, s70, s73
    s_lshl_b32 s58, s70, 8
    s_add_u32 s70, s76, 1
    s_cmp_ge_u32 s70, 5
    s_cselect_b32 s73, 5, 0
    s_sub_u32 s70, s70, s73
    s_lshl_b32 s59, s70, 8
    s_add_u32 s70, s76, 0
    s_cmp_ge_u32 s70, 5
    s_cselect_b32 s73, 5, 0
    s_sub_u32 s70, s70, s73
    s_lshl_b32 s60, s70, 8
    s_waitcnt vmcnt(0)
    s_barrier
    s_add_u32 s71, s0, 5
    v_mov_b32 v242, s71
    buffer_store_dword v242, v243, s[4:7], 0 offen sc1
    s_cmp_lg_u32 s52, 1
    s_cbranch_scc1 L_k5
    buffer_load_dword v244, v241, s[8:11], 0 offen sc1
    s_waitcnt vmcnt(0)
L_c5:
    v_and_b32 v244, 0xff, v244
    v_cmp_le_u32 vcc, 5, v244
    s_nop 0
    s_cmp_eq_u32 vcc_lo, 0xffff
    s_cbranch_scc0 L_s5
L_k5:
    s_barrier
    s_cmp_eq_u32 s52, 3
    s_cbranch_scc1 L_fin
    s_mov_b32 s71, 0
    buffer_load_dwordx4 v[48:51], v223, s[28:31], s71 offen sc1
    s_mov_b32 s71, 98304
    buffer_load_dwordx4 v[52:55], v223, s[28:31], s71 offen sc1
    s_mov_b32 s71, 196608
    buffer_load_dwordx4 v[56:59], v223, s[28:31], s71 offen sc1
    s_mov_b32 s71, 294912
    buffer_load_dwordx4 v[60:63], v223, s[28:31], s71 offen sc1
    s_mov_b32 s71, 24576
    buffer_load_dwordx4 v[64:67], v223, s[28:31], s71 offen sc1
    s_mov_b32 s71, 122880
    buffer_load_dwordx4 v[68:71], v223, s[28:31], s71 offen sc1
    s_mov_b32 s71, 221184
    buffer_load_dwordx4 v[72:75], v223, s[28:31], s71 offen sc1
    s_mov_b32 s71, 319488
    buffer_load_dwordx4 v[76:79], v223, s[28:31], s71 offen sc1
    s_mov_b32 s71, 49152
    buffer_load_dwordx4 v[80:83], v223, s[28:31], s71 offen sc1
    s_mov_b32 s71, 147456
    buffer_load_dwordx4 v[84:87], v223, s[28:31], s71 offen sc1
    s_mov_b32 s71, 245760
    buffer_load_dwordx4 v[88:91], v223, s[28:31], s71 offen sc1
    s_mov_b32 s71, 344064
    buffer_load_dwordx4 v[92:95], v223, s[28:31], s71 offen sc1
    s_mov_b32 s71, 73728
    buffer_load_dwordx4 v[96:99], v223, s[28:31], s71 offen sc1
    s_mov_b32 s71, 172032
    buffer_load_dwordx4 v[100:103], v223, s[28:31], s71 offen sc1
    s_mov_b32 s71, 270336
    buffer_load_dwordx4 v[104:107], v223, s[28:31], s71 offen sc1
    s_mov_b32 s71, 368640
    buffer_load_dwordx4 v[108:111], v223, s[28:31], s71 offen sc1
    s_cmp_lg_u32 s67, 0
    s_cbranch_scc1 L_sp
    s_waitcnt vmcnt(15)
    v_mfma_f32_16x16x32_bf16 v[120:123], v[202:205], v[48:51], 0
    v_mfma_f32_16x16x32_bf16 v[124:127], v[200:203], v[48:51], 0
    s_waitcnt vmcnt(14)
    v_mfma_f32_16x16x32_bf16 v[120:123], v[202:205], v[52:55], v[120:123]
    v_mfma_f32_16x16x32_bf16 v[124:127], v[200:203], v[52:55], v[124:127]
    s_waitcnt vmcnt(13)
    v_mfma_f32_16x16x32_bf16 v[120:123], v[202:205], v[56:59], v[120:123]
    v_mfma_f32_16x16x32_bf16 v[124:127], v[200:203], v[56:59], v[124:127]
    s_waitcnt vmcnt(12)
    v_mfma_f32_16x16x32_bf16 v[120:123], v[202:205], v[60:63], v[120:123]
    v_mfma_f32_16x16x32_bf16 v[124:127], v[200:203], v[60:63], v[124:127]
    s_waitcnt vmcnt(11)
    v_mfma_f32_16x16x32_bf16 v[128:131], v[202:205], v[64:67], 0
    v_mfma_f32_16x16x32_bf16 v[132:135], v[200:203], v[64:67], 0
    s_waitcnt vmcnt(10)
    v_mfma_f32_16x16x32_bf16 v[128:131], v[202:205], v[68:71], v[128:131]
    v_mfma_f32_16x16x32_bf16 v[132:135], v[200:203], v[68:71], v[132:135]
    s_nop 0
    v_cvt_pk_bf16_f32 v120, v120, v121
    v_cvt_pk_bf16_f32 v121, v122, v123
    v_cvt_pk_bf16_f32 v122, v124, v125
    v_cvt_pk_bf16_f32 v123, v126, v127
    s_nop 0
    v_permlane32_swap_b32 v120, v122
    v_permlane32_swap_b32 v121, v123
    s_nop 0
    v_permlane16_swap_b32 v120, v122
    v_permlane16_swap_b32 v121, v123
    buffer_store_dwordx4 v[120:123], v214, s[32:35], s57 offen sc1 nt
    s_waitcnt vmcnt(10)
    v_mfma_f32_16x16x32_bf16 v[128:131], v[202:205], v[72:75], v[128:131]
    v_mfma_f32_16x16x32_bf16 v[132:135], v[200:203], v[72:75], v[132:135]
    s_waitcnt vmcnt(9)
    v_mfma_f32_16x16x32_bf16 v[128:131], v[202:205], v[76:79], v[128:131]
    v_mfma_f32_16x16x32_bf16 v[132:135], v[200:203], v[76:79], v[132:135]
    s_waitcnt vmcnt(8)
    v_mfma_f32_16x16x32_bf16 v[136:139], v[202:205], v[80:83], 0
    v_mfma_f32_16x16x32_bf16 v[140:143], v[200:203], v[80:83], 0
    s_waitcnt vmcnt(7)
    v_mfma_f32_16x16x32_bf16 v[136:139], v[202:205], v[84:87], v[136:139]
    v_mfma_f32_16x16x32_bf16 v[140:143], v[200:203], v[84:87], v[140:143]
    s_nop 0
    v_cvt_pk_bf16_f32 v128, v128, v129
    v_cvt_pk_bf16_f32 v129, v130, v131
    v_cvt_pk_bf16_f32 v130, v132, v133
    v_cvt_pk_bf16_f32 v131, v134, v135
    s_nop 0
    v_permlane32_swap_b32 v128, v130
    v_permlane32_swap_b32 v129, v131
    s_nop 0
    v_permlane16_swap_b32 v128, v130
    v_permlane16_swap_b32 v129, v131
    buffer_store_dwordx4 v[128:131], v214, s[32:35], s58 offen sc1 nt
    s_waitcnt vmcnt(7)
    v_mfma_f32_16x16x32_bf16 v[136:139], v[202:205], v[88:91], v[136:139]
    v_mfma_f32_16x16x32_bf16 v[140:143], v[200:203], v[88:91], v[140:143]
    s_waitcnt vmcnt(6)
    v_mfma_f32_16x16x32_bf16 v[136:139], v[202:205], v[92:95], v[136:139]
    v_mfma_f32_16x16x32_bf16 v[140:143], v[200:203], v[92:95], v[140:143]
    s_waitcnt vmcnt(5)
    v_mfma_f32_16x16x32_bf16 v[144:147], v[202:205], v[96:99], 0
    v_mfma_f32_16x16x32_bf16 v[148:151], v[200:203], v[96:99], 0
    s_waitcnt vmcnt(4)
    v_mfma_f32_16x16x32_bf16 v[144:147], v[202:205], v[100:103], v[144:147]
    v_mfma_f32_16x16x32_bf16 v[148:151], v[200:203], v[100:103], v[148:151]
    s_nop 0
    v_cvt_pk_bf16_f32 v136, v136, v137
    v_cvt_pk_bf16_f32 v137, v138, v139
    v_cvt_pk_bf16_f32 v138, v140, v141
    v_cvt_pk_bf16_f32 v139, v142, v143
    s_nop 0
    v_permlane32_swap_b32 v136, v138
    v_permlane32_swap_b32 v137, v139
    s_nop 0
    v_permlane16_swap_b32 v136, v138
    v_permlane16_swap_b32 v137, v139
    buffer_store_dwordx4 v[136:139], v214, s[32:35], s59 offen sc1 nt
    s_waitcnt vmcnt(4)
    v_mfma_f32_16x16x32_bf16 v[144:147], v[202:205], v[104:107], v[144:147]
    v_mfma_f32_16x16x32_bf16 v[148:151], v[200:203], v[104:107], v[148:151]
    s_waitcnt vmcnt(3)
    v_mfma_f32_16x16x32_bf16 v[144:147], v[202:205], v[108:111], v[144:147]
    v_mfma_f32_16x16x32_bf16 v[148:151], v[200:203], v[108:111], v[148:151]
    s_nop 6
    v_cvt_pk_bf16_f32 v144, v144, v145
    v_cvt_pk_bf16_f32 v145, v146, v147
    v_cvt_pk_bf16_f32 v146, v148, v149
    v_cvt_pk_bf16_f32 v147, v150, v151
    s_nop 0
    v_permlane32_swap_b32 v144, v146
    v_permlane32_swap_b32 v145, v147
    s_nop 0
    v_permlane16_swap_b32 v144, v146
    v_permlane16_swap_b32 v145, v147
    buffer_store_dwordx4 v[144:147], v214, s[32:35], s60 offen sc1 nt
    s_branch L_fin
L_sp:
    s_waitcnt vmcnt(15)
    v_mfma_f32_16x16x32_bf16 v[120:123], v[202:205], v[48:51], 0
    v_mfma_f32_16x16x32_bf16 v[124:127], v[200:203], v[48:51], 0
    s_waitcnt vmcnt(14)
    v_mfma_f32_16x16x32_bf16 v[120:123], v[202:205], v[52:55], v[120:123]
    v_mfma_f32_16x16x32_bf16 v[124:127], v[200:203], v[52:55], v[124:127]
    s_waitcnt vmcnt(13)
    v_mfma_f32_16x16x32_bf16 v[120:123], v[202:205], v[56:59], v[120:123]
    v_mfma_f32_16x16x32_bf16 v[124:127], v[200:203], v[56:59], v[124:127]
    s_waitcnt vmcnt(12)
    v_mfma_f32_16x16x32_bf16 v[120:123], v[202:205], v[60:63], v[120:123]
    v_mfma_f32_16x16x32_bf16 v[124:127], v[200:203], v[60:63], v[124:127]
    s_waitcnt vmcnt(11)
    v_mfma_f32_16x16x32_bf16 v[120:123], v[202:205], v[64:67], v[120:123]
    v_mfma_f32_16x16x32_bf16 v[124:127], v[200:203], v[64:67], v[124:127]
    s_waitcnt vmcnt(10)
    v_mfma_f32_16x16x32_bf16 v[120:123], v[202:205], v[68:71], v[120:123]
    v_mfma_f32_16x16x32_bf16 v[124:127], v[200:203], v[68:71], v[124:127]
    s_waitcnt vmcnt(9)
    v_mfma_f32_16x16x32_bf16 v[120:123], v[202:205], v[72:75], v[120:123]
    v_mfma_f32_16x16x32_bf16 v[124:127], v[200:203], v[72:75], v[124:127]
    s_waitcnt vmcnt(8)
    v_mfma_f32_16x16x32_bf16 v[120:123], v[202:205], v[76:79], v[120:123]
    v_mfma_f32_16x16x32_bf16 v[124:127], v[200:203], v[76:79], v[124:127]
    s_waitcnt vmcnt(7)
    v_mfma_f32_16x16x32_bf16 v[120:123], v[202:205], v[80:83], v[120:123]
    v_mfma_f32_16x16x32_bf16 v[124:127], v[200:203], v[80:83], v[124:127]
    s_waitcnt vmcnt(6)
    v_mfma_f32_16x16x32_bf16 v[120:123], v[202:205], v[84:87], v[120:123]
    v_mfma_f32_16x16x32_bf16 v[124:127], v[200:203], v[84:87], v[124:127]
    s_waitcnt vmcnt(5)
    v_mfma_f32_16x16x32_bf16 v[120:123], v[202:205], v[88:91], v[120:123]
    v_mfma_f32_16x16x32_bf16 v[124:127], v[200:203], v[88:91], v[124:127]
    s_waitcnt vmcnt(4)
    v_mfma_f32_16x16x32_bf16 v[120:123], v[202:205], v[92:95], v[120:123]
    v_mfma_f32_16x16x32_bf16 v[124:127], v[200:203], v[92:95], v[124:127]
    s_waitcnt vmcnt(3)
    v_mfma_f32_16x16x32_bf16 v[120:123], v[202:205], v[96:99], v[120:123]
    v_mfma_f32_16x16x32_bf16 v[124:127], v[200:203], v[96:99], v[124:127]
    s_waitcnt vmcnt(2)
    v_mfma_f32_16x16x32_bf16 v[120:123], v[202:205], v[100:103], v[120:123]
    v_mfma_f32_16x16x32_bf16 v[124:127], v[200:203], v[100:103], v[124:127]
    s_waitcnt vmcnt(1)
    v_mfma_f32_16x16x32_bf16 v[120:123], v[202:205], v[104:107], v[120:123]
    v_mfma_f32_16x16x32_bf16 v[124:127], v[200:203], v[104:107], v[124:127]
    s_waitcnt vmcnt(0)
    v_mfma_f32_16x16x32_bf16 v[120:123], v[202:205], v[108:111], v[120:123]
    v_mfma_f32_16x16x32_bf16 v[124:127], v[200:203], v[108:111], v[124:127]
    s_nop 6
    v_cvt_pk_bf16_f32 v120, v120, v121
    v_cvt_pk_bf16_f32 v121, v122, v123
    v_cvt_pk_bf16_f32 v122, v124, v125
    v_cvt_pk_bf16_f32 v123, v126, v127
    s_nop 0
    v_permlane32_swap_b32 v120, v122
    v_permlane32_swap_b32 v121, v123
    s_nop 0
    v_permlane16_swap_b32 v120, v122
    v_permlane16_swap_b32 v121, v123
    buffer_store_dwordx4 v[120:123], v214, s[32:35], s81 offen sc1 nt
L_fin:
L_exit:
    s_endpgm
L_s0:
    buffer_load_dword v244, off, s[16:19], 0 sc1
    s_add_u32 s73, s73, 1
    s_cmp_lt_u32 s73, 200000
    s_waitcnt vmcnt(0)
    s_cbranch_scc1 L_c0
    s_branch L_k0
L_f1:
    buffer_store_dwordx4 v[0:3], v238, s[28:31], s57 offen offset:0 sc1
    buffer_store_dwordx4 v[8:11], v238, s[28:31], s57 offen offset:1024 sc1
    buffer_store_dwordx4 v[16:19], v238, s[28:31], s57 offen offset:2048 sc1
    buffer_store_dwordx4 v[24:27], v239, s[28:31], s57 offen offset:0 sc1
    buffer_store_dwordx4 v[32:35], v239, s[28:31], s57 offen offset:1024 sc1
    buffer_store_dwordx4 v[40:43], v239, s[28:31], s57 offen offset:2048 sc1
    s_waitcnt vmcnt(0)
    s_barrier
    s_add_u32 s71, s0, 1
    v_mov_b32 v242, s71
    buffer_store_dword v242, v243, s[4:7], 0 offen sc1
    s_branch L_h1
L_f2:
    buffer_store_dwordx4 v[48:51], v238, s[28:31], s58 offen offset:0 sc1
    buffer_store_dwordx4 v[56:59], v238, s[28:31], s58 offen offset:1024 sc1
    buffer_store_dwordx4 v[64:67], v238, s[28:31], s58 offen offset:2048 sc1
    buffer_store_dwordx4 v[72:75], v239, s[28:31], s58 offen offset:0 sc1
    buffer_store_dwordx4 v[80:83], v239, s[28:31], s58 offen offset:1024 sc1
    buffer_store_dwordx4 v[88:91], v239, s[28:31], s58 offen offset:2048 sc1
    s_waitcnt vmcnt(0)
    s_barrier
    s_add_u32 s71, s0, 2
    v_mov_b32 v242, s71
    buffer_store_dword v242, v243, s[4:7], 0 offen sc1
    s_branch L_h2
L_s1:
    buffer_load_dword v244, off, s[8:11], s64 sc1
    s_add_u32 s63, s63, 1
    s_cmp_lt_u32 s63, 200000
    s_waitcnt vmcnt(0)
    s_cbranch_scc1 L_c1
    s_branch L_k1
L_f3:
    buffer_store_dwordx4 v[0:3], v238, s[28:31], s59 offen offset:0 sc1
    buffer_store_dwordx4 v[8:11], v238, s[28:31], s59 offen offset:1024 sc1
    buffer_store_dwordx4 v[16:19], v238, s[28:31], s59 offen offset:2048 sc1
    buffer_store_dwordx4 v[24:27], v239, s[28:31], s59 offen offset:0 sc1
    buffer_store_dwordx4 v[32:35], v239, s[28:31], s59 offen offset:1024 sc1
    buffer_store_dwordx4 v[40:43], v239, s[28:31], s59 offen offset:2048 sc1
    s_waitcnt vmcnt(0)
    s_barrier
    s_add_u32 s71, s0, 3
    v_mov_b32 v242, s71
    buffer_store_dword v242, v243, s[4:7], 0 offen sc1
    s_branch L_h3
L_s2:
    buffer_load_dword v244, off, s[8:11], s64 sc1
    s_add_u32 s63, s63, 1
    s_cmp_lt_u32 s63, 200000
    s_waitcnt vmcnt(0)
    s_cbranch_scc1 L_c2
    s_branch L_k2
L_s3:
    buffer_load_dword v244, off, s[8:11], s65 sc1
    s_add_u32 s63, s63, 1
    s_cmp_lt_u32 s63, 200000
    s_waitcnt vmcnt(0)
    s_cbranch_scc1 L_c3
    s_branch L_k3
L_s5:
    buffer_load_dword v244, v241, s[8:11], 0 offen sc1
    s_add_u32 s63, s63, 1
    s_cmp_lt_u32 s63, 200000
    s_waitcnt vmcnt(0)
    s_cbranch_scc1 L_c5
    s_branch L_k5
L_end:
.section .rodata,"a"
.p2align 6
.amdhsa_kernel concat_heads__gqa_block_cached__mha_block_cached__near_ridge_kernel
  .amdhsa_next_free_vgpr 512
  .amdhsa_next_free_sgpr 102
  .amdhsa_accum_offset 256
  .amdhsa_group_segment_fixed_size 0
  .amdhsa_kernarg_size 104
  .amdhsa_user_sgpr_count 2
  .amdhsa_user_sgpr_kernarg_segment_ptr 1
  .amdhsa_system_sgpr_workgroup_id_x 1
  .amdhsa_float_denorm_mode_32 3
.end_amdhsa_kernel
```
